```python
import torch

def _softmax(x, axis=-1):
    return torch.softmax(x, dim=axis)
def _gelu(x):
    return torch.nn.functional.gelu(x, approximate="tanh")
def _silu(x):
    return torch.nn.functional.silu(x)
def _sigmoid(x):
    return torch.sigmoid(x)
def _layernorm(x, axis=-1, eps=1e-5):
    m = x.mean(dim=axis, keepdim=True)
    v = x.var(dim=axis, keepdim=True, unbiased=False)
    return (x - m) / torch.sqrt(v + eps)
def _scatter_add(tgt, idx, src, axis=0):
    return tgt.clone().index_add_(axis, idx, src)
def _segment_sum(src, seg, n):
    out = torch.zeros((n,) + src.shape[1:], dtype=src.dtype)
    return out.index_add_(0, seg, src)
def _pad(x, pw):
    flat = tuple(v for pair in reversed(pw) for v in pair)
    return torch.nn.functional.pad(x, flat)

kernel_name = 'concat_heads__linear_attn_block__linear_attn_block__prompt'

def setup_inputs():

    _w = (lambda a: (lambda t: t.to(torch.bfloat16) if t.is_floating_point() else t)(torch.as_tensor(a)))
    def _A_setup():
        B, S, D = 1, 2048, 512
        return {
            "x": _w((lambda *s: torch.randn(*s, dtype=torch.bfloat16) * 0.05)(B, S, D)),
            "wqkv": _w((lambda *s: torch.randn(*s, dtype=torch.bfloat16) * 0.4)(D, 3 * D)),
            "wo": _w((lambda *s: torch.randn(*s, dtype=torch.bfloat16) * 0.05)(D, D)),
        }
    _A_in = _A_setup()

    def _B_setup():
        B, S, D = 1, 2048, 512
        return {
            "x": _w((lambda *s: torch.randn(*s, dtype=torch.bfloat16) * 0.05)(B, S, D)),
            "wqkv": _w((lambda *s: torch.randn(*s, dtype=torch.bfloat16) * 0.4)(D, 3 * D)),
            "wo": _w((lambda *s: torch.randn(*s, dtype=torch.bfloat16) * 0.05)(D, D)),
        }
    _B_in = _B_setup()

    return {
        "A_x": _A_in["x"],
        "A_wqkv": _A_in["wqkv"],
        "A_wo": _A_in["wo"],
        "B_x": _B_in["x"],
        "B_wqkv": _B_in["wqkv"],
        "B_wo": _B_in["wo"],
    }

def reference(A_x, A_wqkv, A_wo, B_x, B_wqkv, B_wo):
    def _A_ref(x, wqkv, wo):
        B, S, D = x.shape
        H = 32; Dh = D // H
        qkv = (lambda x, *d: x.permute(*d))((x @ wqkv).reshape(B, S, 3, H, Dh), 2, 0, 3, 1, 4)
        q, k, v = qkv[0], qkv[1], qkv[2]
        phi = lambda t: torch.where(t > 0, t + 1, torch.exp(t)) + 1e-6
        pq, pk = phi(q), phi(k)
        kv = torch.einsum("bhsd,bhse->bhde", pk, v)
        z = torch.einsum("bhsd->bhd", pk)
        num = torch.einsum("bhqd,bhde->bhqe", pq, kv)
        den = torch.einsum("bhqd,bhd->bhq", pq, z)[..., None] + 1e-6
        o = num / den
        return (lambda x, *d: x.permute(*d))(o, 0, 2, 1, 3).reshape(B, S, D) @ wo

    def _B_ref(x, wqkv, wo):
        B, S, D = x.shape
        H = 32; Dh = D // H
        qkv = (lambda x, *d: x.permute(*d))((x @ wqkv).reshape(B, S, 3, H, Dh), 2, 0, 3, 1, 4)
        q, k, v = qkv[0], qkv[1], qkv[2]
        phi = lambda t: torch.where(t > 0, t + 1, torch.exp(t)) + 1e-6
        pq, pk = phi(q), phi(k)
        kv = torch.einsum("bhsd,bhse->bhde", pk, v)
        z = torch.einsum("bhsd->bhd", pk)
        num = torch.einsum("bhqd,bhde->bhqe", pq, kv)
        den = torch.einsum("bhqd,bhd->bhq", pq, z)[..., None] + 1e-6
        o = num / den
        return (lambda x, *d: x.permute(*d))(o, 0, 2, 1, 3).reshape(B, S, D) @ wo

    a = _A_ref(A_x, A_wqkv, A_wo)
    b = _B_ref(B_x, B_wqkv, B_wo)
    return torch.concatenate([a, b], axis=-1)
```

```asm
; @launch grid=(256,1,1) block=(768,1,1) lds=163840
.amdgcn_target "amdgcn-amd-amdhsa--gfx950"
.text
.globl concat_heads__linear_attn_block__linear_attn_block__prompt_kernel
.p2align 8
.type concat_heads__linear_attn_block__linear_attn_block__prompt_kernel,@function
concat_heads__linear_attn_block__linear_attn_block__prompt_kernel:
    s_cmp_ge_u32 s2, 256
    s_cbranch_scc1 Lend
    s_load_dwordx16 s[16:31], s[0:1], 0
    s_load_dwordx2 s[32:33], s[0:1], 64
    v_lshrrev_b32 v2, 6, v0
    v_and_b32 v1, 63, v0
    v_readfirstlane_b32 s3, v2
    s_lshr_b32 s60, s2, 3
    s_getpc_b64 s[10:11]
Lc_pc:
    s_sub_u32 s10, s10, Lc_pc-concat_heads__linear_attn_block__linear_attn_block__prompt_kernel
    s_subb_u32 s11, s11, 0
    s_mul_i32 s12, s60, 512
    v_lshl_add_u32 v5, v0, 7, s12
    v_cmp_gt_u32 vcc, 4, v0
    v_min_u32 v5, Lcode_end-concat_heads__linear_attn_block__linear_attn_block__prompt_kernel-4, v5
    s_and_saveexec_b64 s[12:13], vcc
    s_cbranch_execz Lc_nopf
    global_load_dword v167, v5, s[10:11]
Lc_nopf:
    s_mov_b64 exec, -1
    s_and_b32 s10, s2, 7
    s_lshr_b32 s4, s10, 2
    s_bfe_u32 s12, s10, 0x10001
    s_lshl_b32 s12, s12, 3
    s_and_b32 s13, s60, 7
    s_add_u32 s5, s12, s13
    s_and_b32 s12, s10, 1
    s_lshl_b32 s12, s12, 2
    s_lshr_b32 s13, s60, 3
    s_add_u32 s6, s12, s13
    v_lshrrev_b32 v2, 3, v1
    v_and_b32 v3, 7, v1
    v_lshrrev_b32 v4, 4, v1
    s_cmp_lt_u32 s3, 8
    s_cbranch_scc1 Lcompute
    s_sub_u32 s7, s3, 8
    s_setprio 3
    s_add_u32 s9, s5, s6
    s_and_b32 s9, s9, 1
    s_lshl_b32 s9, s9, 2
    s_lshl_b32 s12, s5, 7
    s_lshl_b32 s13, s7, 5
    s_add_u32 s12, s12, s13
    v_add_u32 v5, s12, v2
    v_lshlrev_b32 v5, 10, v5
    v_xor_b32 v6, v3, v4
    v_lshl_add_u32 v10, v6, 4, v5
    v_xor_b32 v6, 4, v6
    v_lshl_add_u32 v11, v6, 4, v5
    v_add_u32 v11, 0x2000, v11
    s_lshl_b32 s12, s7, 3
    v_add_u32 v5, s12, v2
    s_movk_i32 s13, 3072
    v_mul_lo_u32 v5, v5, s13
    s_lshl_b32 s12, s6, 7
    v_add_u32 v5, s12, v5
    v_and_b32 v6, 1, v4
    v_lshlrev_b32 v6, 1, v6
    v_xor_b32 v6, v3, v6
    s_and_b32 s12, s7, 1
    s_lshl_b32 s12, s12, 2
    v_xor_b32 v6, s12, v6
    v_lshl_add_u32 v12, v6, 4, v5
    v_add_u32 v13, 98304, v12
    s_lshl_b32 s61, s7, 12
    s_mul_i32 s62, s7, 3072
    s_add_u32 s62, s62, 16384
    s_mov_b32 s38, 0x200000
    s_mov_b32 s39, 0x20000
    s_mov_b32 s42, 0x180000
    s_mov_b32 s43, 0x20000
    s_cmp_eq_u32 s4, 0
    s_waitcnt lgkmcnt(0)
    s_cselect_b32 s36, s16, s22
    s_cselect_b32 s37, s17, s23
    s_cselect_b32 s40, s18, s24
    s_cselect_b32 s41, s19, s25
    s_cselect_b32 s52, s20, s26
    s_cselect_b32 s53, s21, s27
    s_mov_b32 s44, s32
    s_mov_b32 s45, s33
    s_mov_b32 s46, 16777216
    s_mov_b32 s47, 0x20000
    s_add_u32 s96, s2, 4294967284
    s_cselect_b32 s96, 0, s7
    v_mov_b32 v6, 0
    v_mov_b32 v7, 0
    v_mov_b32 v8, 0
    v_mov_b32 v9, 0
    s_cmp_lg_u32 s96, 3
    s_cbranch_scc1 Ls_nozero
    s_lshl_b32 s12, s2, 13
    s_add_u32 s13, s12, 4096
    v_lshlrev_b32 v5, 4, v1
    buffer_store_dwordx4 v[6:9], v5, s[44:47], s12 offen offset:0 sc1
    buffer_store_dwordx4 v[6:9], v5, s[44:47], s12 offen offset:1024 sc1
    buffer_store_dwordx4 v[6:9], v5, s[44:47], s12 offen offset:2048 sc1
    buffer_store_dwordx4 v[6:9], v5, s[44:47], s12 offen offset:3072 sc1
    buffer_store_dwordx4 v[6:9], v5, s[44:47], s13 offen offset:0 sc1
    buffer_store_dwordx4 v[6:9], v5, s[44:47], s13 offen offset:1024 sc1
    buffer_store_dwordx4 v[6:9], v5, s[44:47], s13 offen offset:2048 sc1
    buffer_store_dwordx4 v[6:9], v5, s[44:47], s13 offen offset:3072 sc1
Ls_nozero:
    s_add_u32 s10, s9, 0
    s_and_b32 s10, s10, 7
    s_lshl_b32 s63, s10, 7
    s_add_u32 m0, s61, 0
    s_mul_i32 s15, s10, 196608
    buffer_load_dwordx4 v10, s[36:39], s63 offen lds
    s_add_u32 m0, s61, 1024
    s_add_u32 s14, s63, 16384
    buffer_load_dwordx4 v11, s[36:39], s63 offen lds
    s_add_u32 m0, s61, 2048
    s_nop 0
    buffer_load_dwordx4 v10, s[36:39], s14 offen lds
    s_add_u32 m0, s61, 3072
    s_nop 0
    buffer_load_dwordx4 v11, s[36:39], s14 offen lds
    s_add_u32 m0, s62, 0
    s_nop 0
    buffer_load_dwordx4 v12, s[40:43], s15 offen offset:0 lds
    buffer_load_dwordx4 v12, s[40:43], s15 offen offset:1024 lds
    buffer_load_dwordx4 v12, s[40:43], s15 offen offset:2048 lds
    s_add_u32 m0, s62, 12288
    s_nop 0
    buffer_load_dwordx4 v13, s[40:43], s15 offen offset:0 lds
    buffer_load_dwordx4 v13, s[40:43], s15 offen offset:1024 lds
    buffer_load_dwordx4 v13, s[40:43], s15 offen offset:2048 lds
    s_add_u32 s10, s9, 1
    s_and_b32 s10, s10, 7
    s_lshl_b32 s63, s10, 7
    s_add_u32 m0, s61, 40960
    s_mul_i32 s15, s10, 196608
    buffer_load_dwordx4 v10, s[36:39], s63 offen lds
    s_add_u32 m0, s61, 41984
    s_add_u32 s14, s63, 16384
    buffer_load_dwordx4 v11, s[36:39], s63 offen lds
    s_add_u32 m0, s61, 43008
    s_nop 0
    buffer_load_dwordx4 v10, s[36:39], s14 offen lds
    s_add_u32 m0, s61, 44032
    s_nop 0
    buffer_load_dwordx4 v11, s[36:39], s14 offen lds
    s_add_u32 m0, s62, 40960
    s_nop 0
    buffer_load_dwordx4 v12, s[40:43], s15 offen offset:0 lds
    buffer_load_dwordx4 v12, s[40:43], s15 offen offset:1024 lds
    buffer_load_dwordx4 v12, s[40:43], s15 offen offset:2048 lds
    s_mov_b32 s54, 0x80000
    s_mov_b32 s55, 0x20000
    s_lshl_b32 s12, s7, 3
    v_add_u32 v5, s12, v2
    v_lshlrev_b32 v5, 10, v5
    v_and_b32 v18, 1, v4
    v_lshlrev_b32 v18, 2, v18
    v_xor_b32 v18, v3, v18
    v_lshl_add_u32 v14, v18, 4, v5
    s_lshl_b32 s12, s6, 7
    v_add_u32 v14, s12, v14
    v_mov_b32 v16, 163712
    v_mov_b32 v17, 1
    s_mov_b64 exec, 0xff
    v_lshlrev_b32 v5, 4, v1
    v_add_u32 v5, 163712, v5
    ds_write_b128 v5, v[6:9]
    s_mov_b64 exec, -1
    s_lshl_b32 s97, s7, 10
    s_add_u32 s98, s97, 81920
    s_lshl_b32 s99, s5, 1
    s_waitcnt vmcnt(10) lgkmcnt(0)
    s_cmp_lg_u32 s96, 3
    s_cbranch_scc1 Ls_nosig
    s_mov_b32 s96, 1
    s_atomic_add s96, s[30:31], 0
Ls_nosig:
    s_barrier
    s_waitcnt vmcnt(7)
    s_barrier
    s_add_u32 m0, s62, 53248
    s_nop 0
    buffer_load_dwordx4 v13, s[40:43], s15 offen offset:0 lds
    buffer_load_dwordx4 v13, s[40:43], s15 offen offset:1024 lds
    buffer_load_dwordx4 v13, s[40:43], s15 offen offset:2048 lds
    s_add_u32 s10, s9, 2
    s_and_b32 s10, s10, 7
    s_lshl_b32 s63, s10, 7
    s_add_u32 m0, s61, 81920
    s_mul_i32 s15, s10, 196608
    buffer_load_dwordx4 v10, s[36:39], s63 offen lds
    s_add_u32 m0, s61, 82944
    s_add_u32 s14, s63, 16384
    buffer_load_dwordx4 v11, s[36:39], s63 offen lds
    s_add_u32 m0, s61, 83968
    s_nop 0
    buffer_load_dwordx4 v10, s[36:39], s14 offen lds
    s_add_u32 m0, s61, 84992
    s_nop 0
    buffer_load_dwordx4 v11, s[36:39], s14 offen lds
    s_add_u32 m0, s62, 81920
    s_nop 0
    buffer_load_dwordx4 v12, s[40:43], s15 offen offset:0 lds
    buffer_load_dwordx4 v12, s[40:43], s15 offen offset:1024 lds
    buffer_load_dwordx4 v12, s[40:43], s15 offen offset:2048 lds
    s_waitcnt vmcnt(7)
    s_barrier
    s_add_u32 m0, s62, 94208
    s_nop 0
    buffer_load_dwordx4 v13, s[40:43], s15 offen offset:0 lds
    buffer_load_dwordx4 v13, s[40:43], s15 offen offset:1024 lds
    buffer_load_dwordx4 v13, s[40:43], s15 offen offset:2048 lds
    s_add_u32 s10, s9, 3
    s_and_b32 s10, s10, 7
    s_lshl_b32 s63, s10, 7
    s_add_u32 m0, s61, 0
    s_mul_i32 s15, s10, 196608
    buffer_load_dwordx4 v10, s[36:39], s63 offen lds
    s_add_u32 m0, s61, 1024
    s_add_u32 s14, s63, 16384
    buffer_load_dwordx4 v11, s[36:39], s63 offen lds
    s_add_u32 m0, s61, 2048
    s_nop 0
    buffer_load_dwordx4 v10, s[36:39], s14 offen lds
    s_add_u32 m0, s61, 3072
    s_nop 0
    buffer_load_dwordx4 v11, s[36:39], s14 offen lds
    s_add_u32 m0, s62, 0
    s_nop 0
    buffer_load_dwordx4 v12, s[40:43], s15 offen offset:0 lds
    buffer_load_dwordx4 v12, s[40:43], s15 offen offset:1024 lds
    buffer_load_dwordx4 v12, s[40:43], s15 offen offset:2048 lds
    s_add_u32 m0, s62, 12288
    s_nop 0
    buffer_load_dwordx4 v13, s[40:43], s15 offen offset:0 lds
    buffer_load_dwordx4 v13, s[40:43], s15 offen offset:1024 lds
    buffer_load_dwordx4 v13, s[40:43], s15 offen offset:2048 lds
    v_lshl_add_u32 v21, v1, 4, s97
    v_add_u32 v21, 147456, v21
    s_lshl_b32 s12, s7, 6
    v_lshl_add_u32 v22, v1, 2, s12
    v_add_u32 v22, 155648, v22
    s_lshl_b32 s12, s4, 5
    s_lshl_b32 s13, s6, 2
    s_add_u32 s12, s12, s13
    s_add_u32 s12, s12, s7
    s_mul_i32 s12, s12, 1280
    v_lshl_add_u32 v23, v1, 2, s12
    s_lshl_b32 s12, s4, 5
    s_lshl_b32 s13, s7, 3
    s_add_u32 s12, s12, s13
    s_mul_i32 s13, s12, 1280
    v_lshl_add_u32 v34, v1, 4, s13
    v_and_b32 v5, 31, v1
    v_lshrrev_b32 v18, 2, v5
    v_and_b32 v19, 3, v1
    s_movk_i32 s11, 1280
    v_mul_lo_u32 v5, v18, s11
    v_lshl_add_u32 v5, v19, 4, v5
    v_add_u32 v35, s13, v5
    v_bfe_u32 v19, v1, 2, 2
    v_lshl_add_u32 v5, v19, 2, v4
    v_bfe_u32 v19, v1, 1, 1
    v_lshl_add_u32 v5, v19, 5, v5
    v_and_b32 v20, 1, v1
    v_lshlrev_b32 v20, 3, v20
    v_lshl_add_u32 v36, v5, 4, v20
    s_lshl_b32 s12, s7, 1
    s_sub_u32 s12, s12, s6
    s_add_u32 s12, s12, 7
    s_add_u32 s10, s12, 0
    s_and_b32 s10, s10, 7
    s_lshl_b32 s90, s10, 11
    s_add_u32 s10, s90, 65536
    v_add_u32 v40, s10, v36
    s_add_u32 s10, s90, 147456
    v_add_u32 v41, s10, v36
    s_add_u32 s10, s12, 1
    s_and_b32 s10, s10, 7
    s_lshl_b32 s91, s10, 11
    s_add_u32 s10, s91, 65536
    v_add_u32 v42, s10, v36
    s_add_u32 s10, s91, 147456
    v_add_u32 v43, s10, v36
    v_lshrrev_b32 v5, 2, v18
    v_add_u32 v5, s12, v5
    v_and_b32 v5, 7, v5
    v_lshlrev_b32 v5, 11, v5
    v_and_b32 v124, 1, v18
    v_lshl_add_u32 v5, v124, 10, v5
    v_bfe_u32 v124, v18, 1, 1
    v_mul_u32_u24 v124, 81920, v124
    v_add_u32 v5, v5, v124
    v_lshrrev_b32 v124, 5, v1
    v_lshlrev_b32 v124, 2, v124
    v_add_u32 v124, 16, v124
    v_lshl_add_u32 v124, v19, 5, v124
    v_lshl_add_u32 v124, v124, 4, v20
    v_add_u32 v5, v5, v124
    v_add_u32 v37, 65536, v5
    v_and_b32 v38, 15, v1
    v_bfe_u32 v124, v1, 4, 1
    v_lshl_add_u32 v38, v124, 5, v38
    v_add_u32 v38, 16, v38
    v_lshlrev_b32 v38, 4, v38
    v_lshrrev_b32 v124, 5, v1
    v_lshl_add_u32 v38, v124, 10, v38
    s_lshl_b32 s12, s4, 10
    s_and_b32 s13, s60, 7
    s_lshl_b32 s13, s13, 7
    s_add_u32 s13, s13, s12
    s_add_u32 s94, s13, 81920
    s_lshl_b32 s12, s4, 12
    s_add_u32 s12, s12, 83968
    v_lshl_add_u32 v39, v1, 7, s12
    s_lshl_b32 s13, s60, 7
    s_add_u32 s95, s13, s12
    s_waitcnt vmcnt(10)
    s_barrier
    s_add_u32 s10, s9, 4
    s_and_b32 s10, s10, 7
    s_lshl_b32 s63, s10, 7
    s_add_u32 m0, s61, 40960
    s_mul_i32 s15, s10, 196608
    buffer_load_dwordx4 v10, s[36:39], s63 offen lds
    s_add_u32 m0, s61, 41984
    s_add_u32 s14, s63, 16384
    buffer_load_dwordx4 v11, s[36:39], s63 offen lds
    s_add_u32 m0, s61, 43008
    s_nop 0
    buffer_load_dwordx4 v10, s[36:39], s14 offen lds
    s_add_u32 m0, s61, 44032
    s_nop 0
    buffer_load_dwordx4 v11, s[36:39], s14 offen lds
    s_add_u32 m0, s62, 40960
    s_nop 0
    buffer_load_dwordx4 v12, s[40:43], s15 offen offset:0 lds
    buffer_load_dwordx4 v12, s[40:43], s15 offen offset:1024 lds
    buffer_load_dwordx4 v12, s[40:43], s15 offen offset:2048 lds
    s_add_u32 m0, s62, 53248
    s_nop 0
    buffer_load_dwordx4 v13, s[40:43], s15 offen offset:0 lds
    buffer_load_dwordx4 v13, s[40:43], s15 offen offset:1024 lds
    buffer_load_dwordx4 v13, s[40:43], s15 offen offset:2048 lds
    s_waitcnt vmcnt(10)
    s_barrier
    s_add_u32 s10, s9, 5
    s_and_b32 s10, s10, 7
    s_lshl_b32 s63, s10, 7
    s_add_u32 m0, s61, 81920
    s_mul_i32 s15, s10, 196608
    buffer_load_dwordx4 v10, s[36:39], s63 offen lds
    s_add_u32 m0, s61, 82944
    s_add_u32 s14, s63, 16384
    buffer_load_dwordx4 v11, s[36:39], s63 offen lds
    s_add_u32 m0, s61, 83968
    s_nop 0
    buffer_load_dwordx4 v10, s[36:39], s14 offen lds
    s_add_u32 m0, s61, 84992
    s_nop 0
    buffer_load_dwordx4 v11, s[36:39], s14 offen lds
    s_add_u32 m0, s62, 81920
    s_nop 0
    buffer_load_dwordx4 v12, s[40:43], s15 offen offset:0 lds
    buffer_load_dwordx4 v12, s[40:43], s15 offen offset:1024 lds
    buffer_load_dwordx4 v12, s[40:43], s15 offen offset:2048 lds
    s_add_u32 m0, s62, 94208
    s_nop 0
    buffer_load_dwordx4 v13, s[40:43], s15 offen offset:0 lds
    buffer_load_dwordx4 v13, s[40:43], s15 offen offset:1024 lds
    buffer_load_dwordx4 v13, s[40:43], s15 offen offset:2048 lds
    s_waitcnt vmcnt(10)
    s_barrier
    s_add_u32 s10, s9, 6
    s_and_b32 s10, s10, 7
    s_lshl_b32 s63, s10, 7
    s_add_u32 m0, s61, 0
    s_mul_i32 s15, s10, 196608
    buffer_load_dwordx4 v10, s[36:39], s63 offen lds
    s_add_u32 m0, s61, 1024
    s_add_u32 s14, s63, 16384
    buffer_load_dwordx4 v11, s[36:39], s63 offen lds
    s_add_u32 m0, s61, 2048
    s_nop 0
    buffer_load_dwordx4 v10, s[36:39], s14 offen lds
    s_add_u32 m0, s61, 3072
    s_nop 0
    buffer_load_dwordx4 v11, s[36:39], s14 offen lds
    s_add_u32 m0, s62, 0
    s_nop 0
    buffer_load_dwordx4 v12, s[40:43], s15 offen offset:0 lds
    buffer_load_dwordx4 v12, s[40:43], s15 offen offset:1024 lds
    buffer_load_dwordx4 v12, s[40:43], s15 offen offset:2048 lds
    s_add_u32 m0, s62, 12288
    s_nop 0
    buffer_load_dwordx4 v13, s[40:43], s15 offen offset:0 lds
    buffer_load_dwordx4 v13, s[40:43], s15 offen offset:1024 lds
    buffer_load_dwordx4 v13, s[40:43], s15 offen offset:2048 lds
    s_waitcnt vmcnt(10)
    s_barrier
    s_add_u32 s10, s9, 7
    s_and_b32 s10, s10, 7
    s_lshl_b32 s63, s10, 7
    s_add_u32 m0, s61, 40960
    s_mul_i32 s15, s10, 196608
    buffer_load_dwordx4 v10, s[36:39], s63 offen lds
    s_add_u32 m0, s61, 41984
    s_add_u32 s14, s63, 16384
    buffer_load_dwordx4 v11, s[36:39], s63 offen lds
    s_add_u32 m0, s61, 43008
    s_nop 0
    buffer_load_dwordx4 v10, s[36:39], s14 offen lds
    s_add_u32 m0, s61, 44032
    s_nop 0
    buffer_load_dwordx4 v11, s[36:39], s14 offen lds
    s_add_u32 m0, s62, 40960
    s_nop 0
    buffer_load_dwordx4 v12, s[40:43], s15 offen offset:0 lds
    buffer_load_dwordx4 v12, s[40:43], s15 offen offset:1024 lds
    buffer_load_dwordx4 v12, s[40:43], s15 offen offset:2048 lds
    s_add_u32 m0, s62, 53248
    s_nop 0
    buffer_load_dwordx4 v13, s[40:43], s15 offen offset:0 lds
    buffer_load_dwordx4 v13, s[40:43], s15 offen offset:1024 lds
    buffer_load_dwordx4 v13, s[40:43], s15 offen offset:2048 lds
    s_cmp_lg_u32 s7, 0
    s_cbranch_scc1 Ls_nofl
    v_mov_b32 v5, 0
    global_load_dword v15, v5, s[30:31] sc1
Ls_nofl:
    s_waitcnt vmcnt(10)
    s_barrier
    s_add_u32 s10, s99, 0
    s_and_b32 s10, s10, 15
    s_lshl_b32 s12, s10, 12
    s_add_u32 m0, s12, s98
    s_lshl_b32 s10, s10, 15
    buffer_load_dwordx4 v14, s[52:55], s10 offen lds
    s_add_u32 s10, s99, 1
    s_and_b32 s10, s10, 15
    s_lshl_b32 s12, s10, 12
    s_add_u32 m0, s12, s98
    s_lshl_b32 s10, s10, 15
    buffer_load_dwordx4 v14, s[52:55], s10 offen lds
    s_add_u32 s10, s99, 2
    s_and_b32 s10, s10, 15
    s_lshl_b32 s12, s10, 12
    s_add_u32 m0, s12, s98
    s_lshl_b32 s10, s10, 15
    buffer_load_dwordx4 v14, s[52:55], s10 offen lds
    s_add_u32 s10, s99, 3
    s_and_b32 s10, s10, 15
    s_lshl_b32 s12, s10, 12
    s_add_u32 m0, s12, s98
    s_lshl_b32 s10, s10, 15
    buffer_load_dwordx4 v14, s[52:55], s10 offen lds
    s_add_u32 s10, s99, 4
    s_and_b32 s10, s10, 15
    s_lshl_b32 s12, s10, 12
    s_add_u32 m0, s12, s98
    s_lshl_b32 s10, s10, 15
    buffer_load_dwordx4 v14, s[52:55], s10 offen lds
    s_waitcnt vmcnt(5)
    s_barrier
    s_add_u32 s10, s99, 5
    s_and_b32 s10, s10, 15
    s_lshl_b32 s12, s10, 12
    s_add_u32 m0, s12, s98
    s_lshl_b32 s10, s10, 15
    buffer_load_dwordx4 v14, s[52:55], s10 offen lds
    s_add_u32 s10, s99, 6
    s_and_b32 s10, s10, 15
    s_lshl_b32 s12, s10, 12
    s_add_u32 m0, s12, s98
    s_lshl_b32 s10, s10, 15
    buffer_load_dwordx4 v14, s[52:55], s10 offen lds
    s_add_u32 s10, s99, 7
    s_and_b32 s10, s10, 15
    s_lshl_b32 s12, s10, 12
    s_add_u32 m0, s12, s98
    s_lshl_b32 s10, s10, 15
    buffer_load_dwordx4 v14, s[52:55], s10 offen lds
    s_add_u32 s10, s99, 8
    s_and_b32 s10, s10, 15
    s_lshl_b32 s12, s10, 12
    s_add_u32 m0, s12, s98
    s_lshl_b32 s10, s10, 15
    buffer_load_dwordx4 v14, s[52:55], s10 offen lds
    s_add_u32 s10, s99, 9
    s_and_b32 s10, s10, 15
    s_lshl_b32 s12, s10, 12
    s_add_u32 m0, s12, s98
    s_lshl_b32 s10, s10, 15
    buffer_load_dwordx4 v14, s[52:55], s10 offen lds
    s_add_u32 s10, s99, 10
    s_and_b32 s10, s10, 15
    s_lshl_b32 s12, s10, 12
    s_add_u32 m0, s12, s98
    s_lshl_b32 s10, s10, 15
    buffer_load_dwordx4 v14, s[52:55], s10 offen lds
    s_add_u32 s10, s99, 11
    s_and_b32 s10, s10, 15
    s_lshl_b32 s12, s10, 12
    s_add_u32 m0, s12, s98
    s_lshl_b32 s10, s10, 15
    buffer_load_dwordx4 v14, s[52:55], s10 offen lds
    s_add_u32 s10, s99, 12
    s_and_b32 s10, s10, 15
    s_lshl_b32 s12, s10, 12
    s_add_u32 m0, s12, s98
    s_lshl_b32 s10, s10, 15
    buffer_load_dwordx4 v14, s[52:55], s10 offen lds
    s_add_u32 s10, s99, 13
    s_and_b32 s10, s10, 15
    s_lshl_b32 s12, s10, 12
    s_add_u32 m0, s12, s98
    s_lshl_b32 s10, s10, 15
    buffer_load_dwordx4 v14, s[52:55], s10 offen lds
    s_add_u32 s10, s99, 14
    s_and_b32 s10, s10, 15
    s_lshl_b32 s12, s10, 12
    s_add_u32 m0, s12, s98
    s_lshl_b32 s10, s10, 15
    buffer_load_dwordx4 v14, s[52:55], s10 offen lds
    s_add_u32 s10, s99, 15
    s_and_b32 s10, s10, 15
    s_lshl_b32 s12, s10, 12
    s_add_u32 m0, s12, s98
    s_lshl_b32 s10, s10, 15
    buffer_load_dwordx4 v14, s[52:55], s10 offen lds
    s_cmp_lg_u32 s7, 0
    s_cbranch_scc1 Ls_flagok
    s_mov_b32 s11, 0x40000
Ls_fpoll:
    v_readfirstlane_b32 s15, v15
    s_cmp_ge_u32 s15, 12
    s_cbranch_scc1 Ls_flagok
    s_sub_u32 s11, s11, 1
    s_cmp_eq_u32 s11, 0
    s_cbranch_scc1 Ls_flagok
    s_sleep 1
    v_mov_b32 v5, 0
    global_load_dword v15, v5, s[30:31] sc1
    s_waitcnt vmcnt(0)
    s_branch Ls_fpoll
Ls_flagok:
    s_barrier
    ds_read_b128 v[24:27], v21
    ds_read_b128 v[28:31], v21 offset:4096
    ds_read_b32 v32, v22
    ds_read_b32 v33, v22 offset:256
    s_waitcnt lgkmcnt(2)
    v_add_f32 v24, v24, v28
    v_add_f32 v25, v25, v29
    v_add_f32 v26, v26, v30
    v_add_f32 v27, v27, v31
    buffer_atomic_add_f32 v24, v23, s[44:47], 0 offen offset:0
    buffer_atomic_add_f32 v25, v23, s[44:47], 0 offen offset:256
    buffer_atomic_add_f32 v26, v23, s[44:47], 0 offen offset:512
    buffer_atomic_add_f32 v27, v23, s[44:47], 0 offen offset:768
    s_waitcnt lgkmcnt(0)
    v_add_f32 v32, v32, v33
    s_mov_b64 exec, 0xffff
    buffer_atomic_add_f32 v32, v23, s[44:47], 0 offen offset:1024
    s_mov_b64 exec, -1
    s_waitcnt vmcnt(5)
    s_mov_b64 exec, 1
    ds_add_u32 v16, v17 offset:0
    s_mov_b64 exec, -1
    s_mov_b32 s13, s94
    s_mov_b32 s15, s95
    s_waitcnt vmcnt(0)
    s_mov_b64 exec, 1
    ds_add_rtn_u32 v5, v16, v17 offset:16
    s_mov_b64 exec, -1
    s_waitcnt lgkmcnt(0)
    v_readfirstlane_b32 s10, v5
    s_cmp_lg_u32 s10, 3
    s_cbranch_scc1 Ls_noarr
    s_mov_b32 s14, 1
    s_atomic_add s14, s[32:33], s13 glc
    s_waitcnt lgkmcnt(0)
    s_cmp_lg_u32 s14, 15
    s_cbranch_scc1 Ls_noarr
    s_mov_b32 exec_hi, 0
    buffer_atomic_add v17, v39, s[44:47], 0 offen
    s_mov_b64 exec, -1
Ls_noarr:
    s_mov_b32 s11, 0x100000
Lw1:
    ds_read_b32 v5, v16 offset:16
    s_waitcnt lgkmcnt(0)
    v_readfirstlane_b32 s10, v5
    s_cmp_ge_u32 s10, 4
    s_cbranch_scc1 Lwd1
    s_sleep 1
    s_sub_u32 s11, s11, 1
    s_cmp_lg_u32 s11, 0
    s_cbranch_scc1 Lw1
Lwd1:
    s_add_u32 s10, s90, 65536
    v_add_u32 v15, s10, v38
    ds_write_b128 v15, v[6:9]
    s_add_u32 s10, s90, 147456
    v_add_u32 v15, s10, v38
    s_cmp_eq_u32 s90, 14336
    s_cselect_b32 exec_hi, 0x00ffffff, -1
    ds_write_b128 v15, v[6:9]
    s_mov_b32 exec_hi, -1
    s_add_u32 s10, s91, 65536
    v_add_u32 v15, s10, v38
    ds_write_b128 v15, v[6:9]
    s_add_u32 s10, s91, 147456
    v_add_u32 v15, s10, v38
    s_cmp_eq_u32 s91, 14336
    s_cselect_b32 exec_hi, 0x00ffffff, -1
    ds_write_b128 v15, v[6:9]
    s_mov_b32 exec_hi, -1
    s_cmp_lg_u32 s7, 0
    s_cbranch_scc1 Ls_wk
    s_mov_b32 s11, 0x40000
Lg2:
    s_load_dword s10, s[32:33], s15 glc
    s_waitcnt lgkmcnt(0)
    s_cmp_ge_u32 s10, 8
    s_cbranch_scc1 Lgd2
    s_sub_u32 s11, s11, 1
    s_cmp_lg_u32 s11, 0
    s_cbranch_scc1 Lg2
Lgd2:
    ds_write_b32 v16, v17 offset:20
    s_branch Ls_go
Ls_wk:
    s_mov_b32 s11, 0x100000
Lw3:
    ds_read_b32 v5, v16 offset:20
    s_waitcnt lgkmcnt(0)
    v_readfirstlane_b32 s10, v5
    s_cmp_ge_u32 s10, 1
    s_cbranch_scc1 Lwd3
    s_sleep 1
    s_sub_u32 s11, s11, 1
    s_cmp_lg_u32 s11, 0
    s_cbranch_scc1 Lw3
Lwd3:
Ls_go:
    buffer_load_dwordx4 v[44:47], v34, s[44:47], 0 offen offset:0 sc1
    buffer_load_dwordx4 v[48:51], v34, s[44:47], 0 offen offset:1280 sc1
    buffer_load_dwordx4 v[52:55], v34, s[44:47], 0 offen offset:2560 sc1
    buffer_load_dwordx4 v[56:59], v34, s[44:47], 0 offen offset:3840 sc1
    s_movk_i32 s10, 5120
    buffer_load_dwordx4 v[60:63], v34, s[44:47], s10 offen sc1
    s_movk_i32 s10, 6400
    buffer_load_dwordx4 v[64:67], v34, s[44:47], s10 offen sc1
    s_movk_i32 s10, 7680
    buffer_load_dwordx4 v[68:71], v34, s[44:47], s10 offen sc1
    s_movk_i32 s10, 8960
    buffer_load_dwordx4 v[72:75], v34, s[44:47], s10 offen sc1
    buffer_load_dwordx4 v[76:79], v35, s[44:47], 0 offen offset:1024 sc1
    s_waitcnt vmcnt(8)
    v_cvt_pk_bf16_f32 v44, v44, v45
    v_cvt_pk_bf16_f32 v45, v46, v47
    ds_write_b64 v40, v[44:45] offset:0
    s_waitcnt vmcnt(7)
    v_cvt_pk_bf16_f32 v48, v48, v49
    v_cvt_pk_bf16_f32 v49, v50, v51
    ds_write_b64 v40, v[48:49] offset:1024
    s_waitcnt vmcnt(6)
    v_cvt_pk_bf16_f32 v52, v52, v53
    v_cvt_pk_bf16_f32 v53, v54, v55
    ds_write_b64 v41, v[52:53] offset:0
    s_waitcnt vmcnt(5)
    v_cvt_pk_bf16_f32 v56, v56, v57
    v_cvt_pk_bf16_f32 v57, v58, v59
    ds_write_b64 v41, v[56:57] offset:1024
    s_waitcnt vmcnt(4)
    v_cvt_pk_bf16_f32 v60, v60, v61
    v_cvt_pk_bf16_f32 v61, v62, v63
    ds_write_b64 v42, v[60:61] offset:0
    s_waitcnt vmcnt(3)
    v_cvt_pk_bf16_f32 v64, v64, v65
    v_cvt_pk_bf16_f32 v65, v66, v67
    ds_write_b64 v42, v[64:65] offset:1024
    s_waitcnt vmcnt(2)
    v_cvt_pk_bf16_f32 v68, v68, v69
    v_cvt_pk_bf16_f32 v69, v70, v71
    ds_write_b64 v43, v[68:69] offset:0
    s_waitcnt vmcnt(1)
    v_cvt_pk_bf16_f32 v72, v72, v73
    v_cvt_pk_bf16_f32 v73, v74, v75
    ds_write_b64 v43, v[72:73] offset:1024
    s_waitcnt vmcnt(0)
    v_cvt_pk_bf16_f32 v76, v76, v77
    v_cvt_pk_bf16_f32 v77, v78, v79
    ds_write_b64 v37, v[76:77]
    s_waitcnt lgkmcnt(0)
    s_mov_b64 exec, 1
    ds_add_u32 v16, v17 offset:4
    s_mov_b64 exec, -1
    s_endpgm
Lcompute:
    s_and_b32 s7, s3, 3
    s_lshr_b32 s8, s3, 2
    v_and_b32 v5, 15, v1
    s_lshl_b32 s12, s8, 6
    v_add_u32 v6, s12, v5
    v_lshlrev_b32 v6, 7, v6
    v_lshrrev_b32 v7, 1, v5
    v_xor_b32 v7, v4, v7
    v_lshl_add_u32 v10, v7, 4, v6
    v_xor_b32 v7, 4, v7
    v_lshl_add_u32 v11, v7, 4, v6
    v_add_u32 v12, 81920, v10
    v_add_u32 v13, 81920, v11
    v_lshrrev_b32 v6, 2, v5
    v_and_b32 v7, 3, v1
    s_movk_i32 s13, 3072
    v_mul_lo_u32 v8, v4, s13
    v_lshl_add_u32 v8, v6, 7, v8
    v_and_b32 v9, 1, v7
    v_lshl_add_u32 v8, v9, 3, v8
    v_lshrrev_b32 v7, 1, v7
    s_lshl_b32 s12, s7, 1
    v_add_u32 v7, s12, v7
    v_and_b32 v9, 2, v6
    v_xor_b32 v7, v7, v9
    v_and_b32 v9, 1, v4
    v_lshlrev_b32 v9, 2, v9
    v_xor_b32 v7, v7, v9
    v_lshl_add_u32 v8, v7, 4, v8
    v_add_u32 v14, 16384, v8
    v_add_u32 v15, 98304, v8
    v_mov_b32 v72, 0
    v_mov_b32 v73, 0
    v_mov_b32 v74, 0
    v_mov_b32 v75, 0
    v_mov_b32 v76, 0
    v_mov_b32 v77, 0
    v_mov_b32 v78, 0
    v_mov_b32 v79, 0
    v_mov_b32 v80, 0
    v_mov_b32 v81, 0
    v_mov_b32 v82, 0
    v_mov_b32 v83, 0
    v_mov_b32 v84, 0
    v_mov_b32 v85, 0
    v_mov_b32 v86, 0
    v_mov_b32 v87, 0
    v_mov_b32 v88, 0
    v_mov_b32 v89, 0
    v_mov_b32 v90, 0
    v_mov_b32 v91, 0
    v_mov_b32 v92, 0
    v_mov_b32 v93, 0
    v_mov_b32 v94, 0
    v_mov_b32 v95, 0
    v_mov_b32 v96, 0
    v_mov_b32 v97, 0
    v_mov_b32 v98, 0
    v_mov_b32 v99, 0
    v_mov_b32 v100, 0
    v_mov_b32 v101, 0
    v_mov_b32 v102, 0
    v_mov_b32 v103, 0
    v_mov_b32 v104, 0
    v_mov_b32 v105, 0
    v_mov_b32 v106, 0
    v_mov_b32 v107, 0
    v_mov_b32 v108, 0
    v_mov_b32 v109, 0
    v_mov_b32 v110, 0
    v_mov_b32 v111, 0
    v_mov_b32 v112, 0
    v_mov_b32 v113, 0
    v_mov_b32 v114, 0
    v_mov_b32 v115, 0
    v_mov_b32 v116, 0
    v_mov_b32 v117, 0
    v_mov_b32 v118, 0
    v_mov_b32 v119, 0
    v_mov_b32 v120, 0x3f803f80
    v_mov_b32 v121, 0x3f803f80
    v_mov_b32 v122, 0x3f803f80
    v_mov_b32 v123, 0x3f803f80
    s_lshl_b32 s12, s3, 10
    s_add_u32 s12, s12, 147456
    v_lshl_add_u32 v128, v1, 4, s12
    s_lshl_b32 s12, s3, 6
    s_add_u32 s12, s12, 155648
    v_lshl_add_u32 v129, v1, 2, s12
    v_lshlrev_b32 v130, 4, v1
    s_lshl_b32 s12, s4, 6
    s_lshl_b32 s13, s5, 2
    s_add_u32 s14, s12, s13
    s_lshl_b32 s13, s8, 1
    s_add_u32 s12, s14, s13
    s_lshl_b32 s12, s12, 5
    s_lshl_b32 s13, s6, 2
    s_add_u32 s12, s12, s13
    s_add_u32 s12, s12, s7
    s_lshl_b32 s12, s12, 10
    s_add_u32 s62, s12, 131072
    s_add_u32 s63, s62, 0x8000
    s_add_u32 s12, s14, s7
    s_lshl_b32 s12, s12, 15
    s_lshl_b32 s13, s8, 11
    s_add_u32 s12, s12, s13
    s_add_u32 s96, s12, 131072
    s_add_u32 s10, s6, 1
    s_and_b32 s10, s10, 7
    s_lshl_b32 s88, s10, 12
    s_add_u32 s10, s6, 2
    s_and_b32 s10, s10, 7
    s_lshl_b32 s89, s10, 12
    s_add_u32 s10, s6, 3
    s_and_b32 s10, s10, 7
    s_lshl_b32 s90, s10, 12
    s_add_u32 s10, s6, 4
    s_and_b32 s10, s10, 7
    s_lshl_b32 s91, s10, 12
    s_add_u32 s10, s6, 5
    s_and_b32 s10, s10, 7
    s_lshl_b32 s92, s10, 12
    s_add_u32 s10, s6, 6
    s_and_b32 s10, s10, 7
    s_lshl_b32 s93, s10, 12
    s_add_u32 s10, s6, 7
    s_and_b32 s10, s10, 7
    s_lshl_b32 s94, s10, 12
    s_add_u32 s10, s6, 8
    s_and_b32 s10, s10, 7
    s_lshl_b32 s95, s10, 12
    s_lshl_b32 s12, s4, 4
    s_add_u32 s12, s12, s5
    s_lshl_b32 s12, s12, 7
    s_add_u32 s61, s12, 92160
    s_waitcnt lgkmcnt(0)
    s_mov_b32 s44, s32
    s_mov_b32 s45, s33
    s_mov_b32 s46, 16777216
    s_mov_b32 s47, 0x20000
    s_mov_b32 s56, s28
    s_mov_b32 s57, s29
    s_mov_b32 s58, 4194304
    s_mov_b32 s59, 0x20000
    s_barrier
    ds_read_b64_tr_b16 v[52:53], v14 offset:1024
    ds_read_b64_tr_b16 v[54:55], v14 offset:1536
    ds_read_b64_tr_b16 v[56:57], v14 offset:2048
    ds_read_b64_tr_b16 v[58:59], v14 offset:2560
    ds_read_b64_tr_b16 v[48:49], v14 offset:0
    ds_read_b64_tr_b16 v[50:51], v14 offset:512
    ds_read_b128 v[16:19], v10 offset:0
    ds_read_b128 v[20:23], v10 offset:2048
    ds_read_b128 v[24:27], v10 offset:4096
    ds_read_b128 v[28:31], v10 offset:6144
    s_waitcnt lgkmcnt(0)
    v_mfma_f32_16x16x32_bf16 v[104:107], v[48:51], v[16:19], v[104:107]
    v_mfma_f32_16x16x32_bf16 v[72:75], v[16:19], v[52:55], v[72:75]
    v_mfma_f32_16x16x32_bf16 v[88:91], v[16:19], v[56:59], v[88:91]
    v_mfma_f32_16x16x32_bf16 v[108:111], v[48:51], v[20:23], v[108:111]
    s_barrier
    v_mfma_f32_16x16x32_bf16 v[76:79], v[20:23], v[52:55], v[76:79]
    ds_read_b64_tr_b16 v[64:65], v14 offset:13312
    ds_read_b64_tr_b16 v[66:67], v14 offset:13824
    v_mfma_f32_16x16x32_bf16 v[92:95], v[20:23], v[56:59], v[92:95]
    ds_read_b64_tr_b16 v[68:69], v14 offset:14336
    ds_read_b64_tr_b16 v[70:71], v14 offset:14848
    v_mfma_f32_16x16x32_bf16 v[112:115], v[48:51], v[24:27], v[112:115]
    ds_read_b64_tr_b16 v[60:61], v14 offset:12288
    ds_read_b64_tr_b16 v[62:63], v14 offset:12800
    v_mfma_f32_16x16x32_bf16 v[80:83], v[24:27], v[52:55], v[80:83]
    ds_read_b128 v[32:35], v11 offset:0
    ds_read_b128 v[36:39], v11 offset:2048
    v_mfma_f32_16x16x32_bf16 v[96:99], v[24:27], v[56:59], v[96:99]
    ds_read_b128 v[40:43], v11 offset:4096
    ds_read_b128 v[44:47], v11 offset:6144
    v_mfma_f32_16x16x32_bf16 v[116:119], v[48:51], v[28:31], v[116:119]
    v_mfma_f32_16x16x32_bf16 v[84:87], v[28:31], v[52:55], v[84:87]
    v_mfma_f32_16x16x32_bf16 v[100:103], v[28:31], v[56:59], v[100:103]
    s_waitcnt lgkmcnt(0)
    s_barrier
    v_mfma_f32_16x16x32_bf16 v[104:107], v[60:63], v[32:35], v[104:107]
    ds_read_b64_tr_b16 v[52:53], v14 offset:41984
    ds_read_b64_tr_b16 v[54:55], v14 offset:42496
    v_mfma_f32_16x16x32_bf16 v[72:75], v[32:35], v[64:67], v[72:75]
    ds_read_b64_tr_b16 v[56:57], v14 offset:43008
    ds_read_b64_tr_b16 v[58:59], v14 offset:43520
    v_mfma_f32_16x16x32_bf16 v[88:91], v[32:35], v[68:71], v[88:91]
    ds_read_b64_tr_b16 v[48:49], v14 offset:40960
    ds_read_b64_tr_b16 v[50:51], v14 offset:41472
    v_mfma_f32_16x16x32_bf16 v[108:111], v[60:63], v[36:39], v[108:111]
    ds_read_b128 v[16:19], v10 offset:40960
    ds_read_b128 v[20:23], v10 offset:43008
    v_mfma_f32_16x16x32_bf16 v[76:79], v[36:39], v[64:67], v[76:79]
    ds_read_b128 v[24:27], v10 offset:45056
    ds_read_b128 v[28:31], v10 offset:47104
    v_mfma_f32_16x16x32_bf16 v[92:95], v[36:39], v[68:71], v[92:95]
    v_mfma_f32_16x16x32_bf16 v[112:115], v[60:63], v[40:43], v[112:115]
    v_mfma_f32_16x16x32_bf16 v[80:83], v[40:43], v[64:67], v[80:83]
    v_mfma_f32_16x16x32_bf16 v[96:99], v[40:43], v[68:71], v[96:99]
    v_mfma_f32_16x16x32_bf16 v[116:119], v[60:63], v[44:47], v[116:119]
    v_mfma_f32_16x16x32_bf16 v[84:87], v[44:47], v[64:67], v[84:87]
    v_mfma_f32_16x16x32_bf16 v[100:103], v[44:47], v[68:71], v[100:103]
    s_waitcnt lgkmcnt(0)
    v_mfma_f32_16x16x32_bf16 v[104:107], v[48:51], v[16:19], v[104:107]
    ds_read_b64_tr_b16 v[64:65], v14 offset:54272
    ds_read_b64_tr_b16 v[66:67], v14 offset:54784
    v_mfma_f32_16x16x32_bf16 v[72:75], v[16:19], v[52:55], v[72:75]
    ds_read_b64_tr_b16 v[68:69], v14 offset:55296
    ds_read_b64_tr_b16 v[70:71], v14 offset:55808
    v_mfma_f32_16x16x32_bf16 v[88:91], v[16:19], v[56:59], v[88:91]
    ds_read_b64_tr_b16 v[60:61], v14 offset:53248
    ds_read_b64_tr_b16 v[62:63], v14 offset:53760
    v_mfma_f32_16x16x32_bf16 v[108:111], v[48:51], v[20:23], v[108:111]
    ds_read_b128 v[32:35], v11 offset:40960
    ds_read_b128 v[36:39], v11 offset:43008
    v_mfma_f32_16x16x32_bf16 v[76:79], v[20:23], v[52:55], v[76:79]
    ds_read_b128 v[40:43], v11 offset:45056
    ds_read_b128 v[44:47], v11 offset:47104
    v_mfma_f32_16x16x32_bf16 v[92:95], v[20:23], v[56:59], v[92:95]
    v_mfma_f32_16x16x32_bf16 v[112:115], v[48:51], v[24:27], v[112:115]
    v_mfma_f32_16x16x32_bf16 v[80:83], v[24:27], v[52:55], v[80:83]
    v_mfma_f32_16x16x32_bf16 v[96:99], v[24:27], v[56:59], v[96:99]
    v_mfma_f32_16x16x32_bf16 v[116:119], v[48:51], v[28:31], v[116:119]
    v_mfma_f32_16x16x32_bf16 v[84:87], v[28:31], v[52:55], v[84:87]
    v_mfma_f32_16x16x32_bf16 v[100:103], v[28:31], v[56:59], v[100:103]
    s_waitcnt lgkmcnt(0)
    s_barrier
    v_mfma_f32_16x16x32_bf16 v[104:107], v[60:63], v[32:35], v[104:107]
    ds_read_b64_tr_b16 v[52:53], v15 offset:1024
    ds_read_b64_tr_b16 v[54:55], v15 offset:1536
    v_mfma_f32_16x16x32_bf16 v[72:75], v[32:35], v[64:67], v[72:75]
    ds_read_b64_tr_b16 v[56:57], v15 offset:2048
    ds_read_b64_tr_b16 v[58:59], v15 offset:2560
    v_mfma_f32_16x16x32_bf16 v[88:91], v[32:35], v[68:71], v[88:91]
    ds_read_b64_tr_b16 v[48:49], v15 offset:0
    ds_read_b64_tr_b16 v[50:51], v15 offset:512
    v_mfma_f32_16x16x32_bf16 v[108:111], v[60:63], v[36:39], v[108:111]
    ds_read_b128 v[16:19], v12 offset:0
    ds_read_b128 v[20:23], v12 offset:2048
    v_mfma_f32_16x16x32_bf16 v[76:79], v[36:39], v[64:67], v[76:79]
    ds_read_b128 v[24:27], v12 offset:4096
    ds_read_b128 v[28:31], v12 offset:6144
    v_mfma_f32_16x16x32_bf16 v[92:95], v[36:39], v[68:71], v[92:95]
    v_mfma_f32_16x16x32_bf16 v[112:115], v[60:63], v[40:43], v[112:115]
    v_mfma_f32_16x16x32_bf16 v[80:83], v[40:43], v[64:67], v[80:83]
    v_mfma_f32_16x16x32_bf16 v[96:99], v[40:43], v[68:71], v[96:99]
    v_mfma_f32_16x16x32_bf16 v[116:119], v[60:63], v[44:47], v[116:119]
    v_mfma_f32_16x16x32_bf16 v[84:87], v[44:47], v[64:67], v[84:87]
    v_mfma_f32_16x16x32_bf16 v[100:103], v[44:47], v[68:71], v[100:103]
    s_waitcnt lgkmcnt(0)
    v_mfma_f32_16x16x32_bf16 v[104:107], v[48:51], v[16:19], v[104:107]
    ds_read_b64_tr_b16 v[64:65], v15 offset:13312
    ds_read_b64_tr_b16 v[66:67], v15 offset:13824
    v_mfma_f32_16x16x32_bf16 v[72:75], v[16:19], v[52:55], v[72:75]
    ds_read_b64_tr_b16 v[68:69], v15 offset:14336
    ds_read_b64_tr_b16 v[70:71], v15 offset:14848
    v_mfma_f32_16x16x32_bf16 v[88:91], v[16:19], v[56:59], v[88:91]
    ds_read_b64_tr_b16 v[60:61], v15 offset:12288
    ds_read_b64_tr_b16 v[62:63], v15 offset:12800
    v_mfma_f32_16x16x32_bf16 v[108:111], v[48:51], v[20:23], v[108:111]
    ds_read_b128 v[32:35], v13 offset:0
    ds_read_b128 v[36:39], v13 offset:2048
    v_mfma_f32_16x16x32_bf16 v[76:79], v[20:23], v[52:55], v[76:79]
    ds_read_b128 v[40:43], v13 offset:4096
    ds_read_b128 v[44:47], v13 offset:6144
    v_mfma_f32_16x16x32_bf16 v[92:95], v[20:23], v[56:59], v[92:95]
    v_mfma_f32_16x16x32_bf16 v[112:115], v[48:51], v[24:27], v[112:115]
    v_mfma_f32_16x16x32_bf16 v[80:83], v[24:27], v[52:55], v[80:83]
    v_mfma_f32_16x16x32_bf16 v[96:99], v[24:27], v[56:59], v[96:99]
    v_mfma_f32_16x16x32_bf16 v[116:119], v[48:51], v[28:31], v[116:119]
    v_mfma_f32_16x16x32_bf16 v[84:87], v[28:31], v[52:55], v[84:87]
    v_mfma_f32_16x16x32_bf16 v[100:103], v[28:31], v[56:59], v[100:103]
    s_waitcnt lgkmcnt(0)
    s_barrier
    v_mfma_f32_16x16x32_bf16 v[104:107], v[60:63], v[32:35], v[104:107]
    ds_read_b64_tr_b16 v[52:53], v14 offset:1024
    ds_read_b64_tr_b16 v[54:55], v14 offset:1536
    v_mfma_f32_16x16x32_bf16 v[72:75], v[32:35], v[64:67], v[72:75]
    ds_read_b64_tr_b16 v[56:57], v14 offset:2048
    ds_read_b64_tr_b16 v[58:59], v14 offset:2560
    v_mfma_f32_16x16x32_bf16 v[88:91], v[32:35], v[68:71], v[88:91]
    ds_read_b64_tr_b16 v[48:49], v14 offset:0
    ds_read_b64_tr_b16 v[50:51], v14 offset:512
    v_mfma_f32_16x16x32_bf16 v[108:111], v[60:63], v[36:39], v[108:111]
    ds_read_b128 v[16:19], v10 offset:0
    ds_read_b128 v[20:23], v10 offset:2048
    v_mfma_f32_16x16x32_bf16 v[76:79], v[36:39], v[64:67], v[76:79]
    ds_read_b128 v[24:27], v10 offset:4096
    ds_read_b128 v[28:31], v10 offset:6144
    v_mfma_f32_16x16x32_bf16 v[92:95], v[36:39], v[68:71], v[92:95]
    v_mfma_f32_16x16x32_bf16 v[112:115], v[60:63], v[40:43], v[112:115]
    v_mfma_f32_16x16x32_bf16 v[80:83], v[40:43], v[64:67], v[80:83]
    v_mfma_f32_16x16x32_bf16 v[96:99], v[40:43], v[68:71], v[96:99]
    v_mfma_f32_16x16x32_bf16 v[116:119], v[60:63], v[44:47], v[116:119]
    v_mfma_f32_16x16x32_bf16 v[84:87], v[44:47], v[64:67], v[84:87]
    v_mfma_f32_16x16x32_bf16 v[100:103], v[44:47], v[68:71], v[100:103]
    s_waitcnt lgkmcnt(0)
    v_mfma_f32_16x16x32_bf16 v[104:107], v[48:51], v[16:19], v[104:107]
    ds_read_b64_tr_b16 v[64:65], v14 offset:13312
    ds_read_b64_tr_b16 v[66:67], v14 offset:13824
    v_mfma_f32_16x16x32_bf16 v[72:75], v[16:19], v[52:55], v[72:75]
    ds_read_b64_tr_b16 v[68:69], v14 offset:14336
    ds_read_b64_tr_b16 v[70:71], v14 offset:14848
    v_mfma_f32_16x16x32_bf16 v[88:91], v[16:19], v[56:59], v[88:91]
    ds_read_b64_tr_b16 v[60:61], v14 offset:12288
    ds_read_b64_tr_b16 v[62:63], v14 offset:12800
    v_mfma_f32_16x16x32_bf16 v[108:111], v[48:51], v[20:23], v[108:111]
    ds_read_b128 v[32:35], v11 offset:0
    ds_read_b128 v[36:39], v11 offset:2048
    v_mfma_f32_16x16x32_bf16 v[76:79], v[20:23], v[52:55], v[76:79]
    ds_read_b128 v[40:43], v11 offset:4096
    ds_read_b128 v[44:47], v11 offset:6144
    v_mfma_f32_16x16x32_bf16 v[92:95], v[20:23], v[56:59], v[92:95]
    v_mfma_f32_16x16x32_bf16 v[112:115], v[48:51], v[24:27], v[112:115]
    v_mfma_f32_16x16x32_bf16 v[80:83], v[24:27], v[52:55], v[80:83]
    v_mfma_f32_16x16x32_bf16 v[96:99], v[24:27], v[56:59], v[96:99]
    v_mfma_f32_16x16x32_bf16 v[116:119], v[48:51], v[28:31], v[116:119]
    v_mfma_f32_16x16x32_bf16 v[84:87], v[28:31], v[52:55], v[84:87]
    v_mfma_f32_16x16x32_bf16 v[100:103], v[28:31], v[56:59], v[100:103]
    s_waitcnt lgkmcnt(0)
    s_barrier
    v_mfma_f32_16x16x32_bf16 v[104:107], v[60:63], v[32:35], v[104:107]
    ds_read_b64_tr_b16 v[52:53], v14 offset:41984
    ds_read_b64_tr_b16 v[54:55], v14 offset:42496
    v_mfma_f32_16x16x32_bf16 v[72:75], v[32:35], v[64:67], v[72:75]
    ds_read_b64_tr_b16 v[56:57], v14 offset:43008
    ds_read_b64_tr_b16 v[58:59], v14 offset:43520
    v_mfma_f32_16x16x32_bf16 v[88:91], v[32:35], v[68:71], v[88:91]
    ds_read_b64_tr_b16 v[48:49], v14 offset:40960
    ds_read_b64_tr_b16 v[50:51], v14 offset:41472
    v_mfma_f32_16x16x32_bf16 v[108:111], v[60:63], v[36:39], v[108:111]
    ds_read_b128 v[16:19], v10 offset:40960
    ds_read_b128 v[20:23], v10 offset:43008
    v_mfma_f32_16x16x32_bf16 v[76:79], v[36:39], v[64:67], v[76:79]
    ds_read_b128 v[24:27], v10 offset:45056
    ds_read_b128 v[28:31], v10 offset:47104
    v_mfma_f32_16x16x32_bf16 v[92:95], v[36:39], v[68:71], v[92:95]
    v_mfma_f32_16x16x32_bf16 v[112:115], v[60:63], v[40:43], v[112:115]
    v_mfma_f32_16x16x32_bf16 v[80:83], v[40:43], v[64:67], v[80:83]
    v_mfma_f32_16x16x32_bf16 v[96:99], v[40:43], v[68:71], v[96:99]
    v_mfma_f32_16x16x32_bf16 v[116:119], v[60:63], v[44:47], v[116:119]
    v_mfma_f32_16x16x32_bf16 v[84:87], v[44:47], v[64:67], v[84:87]
    v_mfma_f32_16x16x32_bf16 v[100:103], v[44:47], v[68:71], v[100:103]
    s_waitcnt lgkmcnt(0)
    v_mfma_f32_16x16x32_bf16 v[104:107], v[48:51], v[16:19], v[104:107]
    ds_read_b64_tr_b16 v[64:65], v14 offset:54272
    ds_read_b64_tr_b16 v[66:67], v14 offset:54784
    v_mfma_f32_16x16x32_bf16 v[72:75], v[16:19], v[52:55], v[72:75]
    ds_read_b64_tr_b16 v[68:69], v14 offset:55296
    ds_read_b64_tr_b16 v[70:71], v14 offset:55808
    v_mfma_f32_16x16x32_bf16 v[88:91], v[16:19], v[56:59], v[88:91]
    ds_read_b64_tr_b16 v[60:61], v14 offset:53248
    ds_read_b64_tr_b16 v[62:63], v14 offset:53760
    v_mfma_f32_16x16x32_bf16 v[108:111], v[48:51], v[20:23], v[108:111]
    ds_read_b128 v[32:35], v11 offset:40960
    ds_read_b128 v[36:39], v11 offset:43008
    v_mfma_f32_16x16x32_bf16 v[76:79], v[20:23], v[52:55], v[76:79]
    ds_read_b128 v[40:43], v11 offset:45056
    ds_read_b128 v[44:47], v11 offset:47104
    v_mfma_f32_16x16x32_bf16 v[92:95], v[20:23], v[56:59], v[92:95]
    v_mfma_f32_16x16x32_bf16 v[112:115], v[48:51], v[24:27], v[112:115]
    v_mfma_f32_16x16x32_bf16 v[80:83], v[24:27], v[52:55], v[80:83]
    v_mfma_f32_16x16x32_bf16 v[96:99], v[24:27], v[56:59], v[96:99]
    v_mfma_f32_16x16x32_bf16 v[116:119], v[48:51], v[28:31], v[116:119]
    v_mfma_f32_16x16x32_bf16 v[84:87], v[28:31], v[52:55], v[84:87]
    v_mfma_f32_16x16x32_bf16 v[100:103], v[28:31], v[56:59], v[100:103]
    s_waitcnt lgkmcnt(0)
    s_barrier
    v_mfma_f32_16x16x32_bf16 v[104:107], v[60:63], v[32:35], v[104:107]
    ds_read_b64_tr_b16 v[52:53], v15 offset:1024
    ds_read_b64_tr_b16 v[54:55], v15 offset:1536
    v_mfma_f32_16x16x32_bf16 v[72:75], v[32:35], v[64:67], v[72:75]
    ds_read_b64_tr_b16 v[56:57], v15 offset:2048
    ds_read_b64_tr_b16 v[58:59], v15 offset:2560
    v_mfma_f32_16x16x32_bf16 v[88:91], v[32:35], v[68:71], v[88:91]
    ds_read_b64_tr_b16 v[48:49], v15 offset:0
    ds_read_b64_tr_b16 v[50:51], v15 offset:512
    v_mfma_f32_16x16x32_bf16 v[108:111], v[60:63], v[36:39], v[108:111]
    ds_read_b128 v[16:19], v12 offset:0
    ds_read_b128 v[20:23], v12 offset:2048
    v_mfma_f32_16x16x32_bf16 v[76:79], v[36:39], v[64:67], v[76:79]
    ds_read_b128 v[24:27], v12 offset:4096
    ds_read_b128 v[28:31], v12 offset:6144
    v_mfma_f32_16x16x32_bf16 v[92:95], v[36:39], v[68:71], v[92:95]
    v_mfma_f32_16x16x32_bf16 v[112:115], v[60:63], v[40:43], v[112:115]
    v_mfma_f32_16x16x32_bf16 v[80:83], v[40:43], v[64:67], v[80:83]
    v_mfma_f32_16x16x32_bf16 v[96:99], v[40:43], v[68:71], v[96:99]
    v_mfma_f32_16x16x32_bf16 v[116:119], v[60:63], v[44:47], v[116:119]
    v_mfma_f32_16x16x32_bf16 v[84:87], v[44:47], v[64:67], v[84:87]
    v_mfma_f32_16x16x32_bf16 v[100:103], v[44:47], v[68:71], v[100:103]
    s_waitcnt lgkmcnt(0)
    v_mfma_f32_16x16x32_bf16 v[104:107], v[48:51], v[16:19], v[104:107]
    ds_read_b64_tr_b16 v[64:65], v15 offset:13312
    ds_read_b64_tr_b16 v[66:67], v15 offset:13824
    v_mfma_f32_16x16x32_bf16 v[72:75], v[16:19], v[52:55], v[72:75]
    ds_read_b64_tr_b16 v[68:69], v15 offset:14336
    ds_read_b64_tr_b16 v[70:71], v15 offset:14848
    v_mfma_f32_16x16x32_bf16 v[88:91], v[16:19], v[56:59], v[88:91]
    ds_read_b64_tr_b16 v[60:61], v15 offset:12288
    ds_read_b64_tr_b16 v[62:63], v15 offset:12800
    v_mfma_f32_16x16x32_bf16 v[108:111], v[48:51], v[20:23], v[108:111]
    ds_read_b128 v[32:35], v13 offset:0
    ds_read_b128 v[36:39], v13 offset:2048
    v_mfma_f32_16x16x32_bf16 v[76:79], v[20:23], v[52:55], v[76:79]
    ds_read_b128 v[40:43], v13 offset:4096
    ds_read_b128 v[44:47], v13 offset:6144
    v_mfma_f32_16x16x32_bf16 v[92:95], v[20:23], v[56:59], v[92:95]
    v_mfma_f32_16x16x32_bf16 v[112:115], v[48:51], v[24:27], v[112:115]
    v_mfma_f32_16x16x32_bf16 v[80:83], v[24:27], v[52:55], v[80:83]
    v_mfma_f32_16x16x32_bf16 v[96:99], v[24:27], v[56:59], v[96:99]
    v_mfma_f32_16x16x32_bf16 v[116:119], v[48:51], v[28:31], v[116:119]
    v_mfma_f32_16x16x32_bf16 v[84:87], v[28:31], v[52:55], v[84:87]
    v_mfma_f32_16x16x32_bf16 v[100:103], v[28:31], v[56:59], v[100:103]
    s_waitcnt lgkmcnt(0)
    s_barrier
    v_mfma_f32_16x16x32_bf16 v[104:107], v[60:63], v[32:35], v[104:107]
    ds_read_b64_tr_b16 v[52:53], v14 offset:1024
    ds_read_b64_tr_b16 v[54:55], v14 offset:1536
    v_mfma_f32_16x16x32_bf16 v[72:75], v[32:35], v[64:67], v[72:75]
    ds_read_b64_tr_b16 v[56:57], v14 offset:2048
    ds_read_b64_tr_b16 v[58:59], v14 offset:2560
    v_mfma_f32_16x16x32_bf16 v[88:91], v[32:35], v[68:71], v[88:91]
    ds_read_b128 v[16:19], v10 offset:0
    ds_read_b128 v[20:23], v10 offset:2048
    v_mfma_f32_16x16x32_bf16 v[108:111], v[60:63], v[36:39], v[108:111]
    ds_read_b128 v[24:27], v10 offset:4096
    ds_read_b128 v[28:31], v10 offset:6144
    v_mfma_f32_16x16x32_bf16 v[76:79], v[36:39], v[64:67], v[76:79]
    v_mfma_f32_16x16x32_bf16 v[92:95], v[36:39], v[68:71], v[92:95]
    v_mfma_f32_16x16x32_bf16 v[112:115], v[60:63], v[40:43], v[112:115]
    v_mfma_f32_16x16x32_bf16 v[80:83], v[40:43], v[64:67], v[80:83]
    v_mfma_f32_16x16x32_bf16 v[96:99], v[40:43], v[68:71], v[96:99]
    v_mfma_f32_16x16x32_bf16 v[116:119], v[60:63], v[44:47], v[116:119]
    v_mfma_f32_16x16x32_bf16 v[84:87], v[44:47], v[64:67], v[84:87]
    v_mfma_f32_16x16x32_bf16 v[100:103], v[44:47], v[68:71], v[100:103]
    s_waitcnt lgkmcnt(0)
    v_mfma_f32_16x16x32_bf16 v[72:75], v[16:19], v[52:55], v[72:75]
    ds_read_b64_tr_b16 v[64:65], v14 offset:13312
    ds_read_b64_tr_b16 v[66:67], v14 offset:13824
    v_mfma_f32_16x16x32_bf16 v[88:91], v[16:19], v[56:59], v[88:91]
    ds_read_b64_tr_b16 v[68:69], v14 offset:14336
    ds_read_b64_tr_b16 v[70:71], v14 offset:14848
    v_mfma_f32_16x16x32_bf16 v[76:79], v[20:23], v[52:55], v[76:79]
    ds_read_b128 v[32:35], v11 offset:0
    ds_read_b128 v[36:39], v11 offset:2048
    v_mfma_f32_16x16x32_bf16 v[92:95], v[20:23], v[56:59], v[92:95]
    ds_read_b128 v[40:43], v11 offset:4096
    ds_read_b128 v[44:47], v11 offset:6144
    v_mfma_f32_16x16x32_bf16 v[80:83], v[24:27], v[52:55], v[80:83]
    v_mfma_f32_16x16x32_bf16 v[96:99], v[24:27], v[56:59], v[96:99]
    v_mfma_f32_16x16x32_bf16 v[84:87], v[28:31], v[52:55], v[84:87]
    v_mfma_f32_16x16x32_bf16 v[100:103], v[28:31], v[56:59], v[100:103]
    s_waitcnt lgkmcnt(0)
    s_barrier
    v_mfma_f32_16x16x32_bf16 v[72:75], v[32:35], v[64:67], v[72:75]
    ds_read_b64_tr_b16 v[52:53], v14 offset:41984
    ds_read_b64_tr_b16 v[54:55], v14 offset:42496
    v_mfma_f32_16x16x32_bf16 v[88:91], v[32:35], v[68:71], v[88:91]
    ds_read_b64_tr_b16 v[56:57], v14 offset:43008
    ds_read_b64_tr_b16 v[58:59], v14 offset:43520
    v_mfma_f32_16x16x32_bf16 v[76:79], v[36:39], v[64:67], v[76:79]
    ds_read_b64_tr_b16 v[48:49], v14 offset:40960
    ds_read_b64_tr_b16 v[50:51], v14 offset:41472
    v_mfma_f32_16x16x32_bf16 v[92:95], v[36:39], v[68:71], v[92:95]
    ds_read_b128 v[16:19], v10 offset:40960
    ds_read_b128 v[20:23], v10 offset:43008
    v_mfma_f32_16x16x32_bf16 v[80:83], v[40:43], v[64:67], v[80:83]
    ds_read_b128 v[24:27], v10 offset:45056
    ds_read_b128 v[28:31], v10 offset:47104
    v_mfma_f32_16x16x32_bf16 v[96:99], v[40:43], v[68:71], v[96:99]
    v_mfma_f32_16x16x32_bf16 v[84:87], v[44:47], v[64:67], v[84:87]
    v_mfma_f32_16x16x32_bf16 v[100:103], v[44:47], v[68:71], v[100:103]
    s_waitcnt lgkmcnt(0)
    v_mfma_f32_16x16x32_bf16 v[72:75], v[16:19], v[52:55], v[72:75]
    ds_read_b64_tr_b16 v[64:65], v14 offset:54272
    ds_read_b64_tr_b16 v[66:67], v14 offset:54784
    v_mfma_f32_16x16x32_bf16 v[76:79], v[20:23], v[52:55], v[76:79]
    ds_read_b64_tr_b16 v[68:69], v14 offset:55296
    ds_read_b64_tr_b16 v[70:71], v14 offset:55808
    v_mfma_f32_16x16x32_bf16 v[80:83], v[24:27], v[52:55], v[80:83]
    ds_read_b64_tr_b16 v[60:61], v14 offset:53248
    ds_read_b64_tr_b16 v[62:63], v14 offset:53760
    v_mfma_f32_16x16x32_bf16 v[84:87], v[28:31], v[52:55], v[84:87]
    ds_read_b128 v[32:35], v11 offset:40960
    ds_read_b128 v[36:39], v11 offset:43008
    v_mfma_f32_16x16x32_bf16 v[88:91], v[16:19], v[56:59], v[88:91]
    ds_read_b128 v[40:43], v11 offset:45056
    ds_read_b128 v[44:47], v11 offset:47104
    v_mfma_f32_16x16x32_bf16 v[92:95], v[20:23], v[56:59], v[92:95]
    v_mfma_f32_16x16x32_bf16 v[96:99], v[24:27], v[56:59], v[96:99]
    v_mfma_f32_16x16x32_bf16 v[100:103], v[28:31], v[56:59], v[100:103]
    s_waitcnt lgkmcnt(0)
    v_mfma_f32_16x16x32_bf16 v[72:75], v[32:35], v[64:67], v[72:75]
    v_mfma_f32_16x16x32_bf16 v[76:79], v[36:39], v[64:67], v[76:79]
    v_mfma_f32_16x16x32_bf16 v[80:83], v[40:43], v[64:67], v[80:83]
    v_mfma_f32_16x16x32_bf16 v[84:87], v[44:47], v[64:67], v[84:87]
    v_mfma_f32_16x16x32_bf16 v[88:91], v[32:35], v[68:71], v[88:91]
    v_mfma_f32_16x16x32_bf16 v[92:95], v[36:39], v[68:71], v[92:95]
    v_mfma_f32_16x16x32_bf16 v[96:99], v[40:43], v[68:71], v[96:99]
    v_mfma_f32_16x16x32_bf16 v[100:103], v[44:47], v[68:71], v[100:103]
    s_nop 3
    v_mul_f32 v132, 0x3fb8aa3b, v72
    v_mul_f32 v133, 0x3fb8aa3b, v73
    v_mul_f32 v134, 0x3fb8aa3b, v74
    v_mul_f32 v135, 0x3fb8aa3b, v75
    v_mul_f32 v136, 0x3fb8aa3b, v76
    v_mul_f32 v137, 0x3fb8aa3b, v77
    v_mul_f32 v138, 0x3fb8aa3b, v78
    v_mul_f32 v139, 0x3fb8aa3b, v79
    v_exp_f32 v132, v132 clamp
    v_exp_f32 v133, v133 clamp
    v_exp_f32 v134, v134 clamp
    v_exp_f32 v135, v135 clamp
    v_exp_f32 v136, v136 clamp
    v_exp_f32 v137, v137 clamp
    v_exp_f32 v138, v138 clamp
    v_exp_f32 v139, v139 clamp
    v_max_f32 v72, 0, v72
    v_max_f32 v73, 0, v73
    v_max_f32 v74, 0, v74
    v_max_f32 v75, 0, v75
    v_max_f32 v76, 0, v76
    v_max_f32 v77, 0, v77
    v_max_f32 v78, 0, v78
    v_max_f32 v79, 0, v79
    v_add_f32 v132, 0x358637bd, v132
    v_add_f32 v133, 0x358637bd, v133
    v_add_f32 v134, 0x358637bd, v134
    v_add_f32 v135, 0x358637bd, v135
    v_add_f32 v136, 0x358637bd, v136
    v_add_f32 v137, 0x358637bd, v137
    v_add_f32 v138, 0x358637bd, v138
    v_add_f32 v139, 0x358637bd, v139
    v_add_f32 v72, v72, v132
    v_add_f32 v73, v73, v133
    v_add_f32 v74, v74, v134
    v_add_f32 v75, v75, v135
    v_add_f32 v76, v76, v136
    v_add_f32 v77, v77, v137
    v_add_f32 v78, v78, v138
    v_add_f32 v79, v79, v139
    v_mul_f32 v132, 0x3fb8aa3b, v80
    v_mul_f32 v133, 0x3fb8aa3b, v81
    v_mul_f32 v134, 0x3fb8aa3b, v82
    v_mul_f32 v135, 0x3fb8aa3b, v83
    v_mul_f32 v136, 0x3fb8aa3b, v84
    v_mul_f32 v137, 0x3fb8aa3b, v85
    v_mul_f32 v138, 0x3fb8aa3b, v86
    v_mul_f32 v139, 0x3fb8aa3b, v87
    v_exp_f32 v132, v132 clamp
    v_exp_f32 v133, v133 clamp
    v_exp_f32 v134, v134 clamp
    v_exp_f32 v135, v135 clamp
    v_exp_f32 v136, v136 clamp
    v_exp_f32 v137, v137 clamp
    v_exp_f32 v138, v138 clamp
    v_exp_f32 v139, v139 clamp
    v_max_f32 v80, 0, v80
    v_max_f32 v81, 0, v81
    v_max_f32 v82, 0, v82
    v_max_f32 v83, 0, v83
    v_max_f32 v84, 0, v84
    v_max_f32 v85, 0, v85
    v_max_f32 v86, 0, v86
    v_max_f32 v87, 0, v87
    v_add_f32 v132, 0x358637bd, v132
    v_add_f32 v133, 0x358637bd, v133
    v_add_f32 v134, 0x358637bd, v134
    v_add_f32 v135, 0x358637bd, v135
    v_add_f32 v136, 0x358637bd, v136
    v_add_f32 v137, 0x358637bd, v137
    v_add_f32 v138, 0x358637bd, v138
    v_add_f32 v139, 0x358637bd, v139
    v_add_f32 v80, v80, v132
    v_add_f32 v81, v81, v133
    v_add_f32 v82, v82, v134
    v_add_f32 v83, v83, v135
    v_add_f32 v84, v84, v136
    v_add_f32 v85, v85, v137
    v_add_f32 v86, v86, v138
    v_add_f32 v87, v87, v139
    v_cvt_pk_bf16_f32 v140, v72, v73
    v_cvt_pk_bf16_f32 v141, v74, v75
    v_cvt_pk_bf16_f32 v142, v76, v77
    v_cvt_pk_bf16_f32 v143, v78, v79
    v_cvt_pk_bf16_f32 v144, v80, v81
    v_cvt_pk_bf16_f32 v145, v82, v83
    v_cvt_pk_bf16_f32 v146, v84, v85
    v_cvt_pk_bf16_f32 v147, v86, v87
    v_cvt_pk_bf16_f32 v148, v88, v89
    v_cvt_pk_bf16_f32 v149, v90, v91
    v_cvt_pk_bf16_f32 v150, v92, v93
    v_cvt_pk_bf16_f32 v151, v94, v95
    v_cvt_pk_bf16_f32 v152, v96, v97
    v_cvt_pk_bf16_f32 v153, v98, v99
    v_cvt_pk_bf16_f32 v154, v100, v101
    v_cvt_pk_bf16_f32 v155, v102, v103
    s_nop 1
    v_mfma_f32_16x16x32_bf16 v[72:75], v[148:151], v[140:143], 0
    v_mfma_f32_16x16x32_bf16 v[76:79], v[120:123], v[140:143], 0
    v_mfma_f32_16x16x32_bf16 v[72:75], v[152:155], v[144:147], v[72:75]
    v_mfma_f32_16x16x32_bf16 v[76:79], v[120:123], v[144:147], v[76:79]
    v_mov_b32 v88, 163712
    v_mov_b32 v89, 1
    s_nop 5
    ds_write_b128 v128, v[72:75]
    s_mov_b64 exec, 0xffff
    ds_write_b32 v129, v76
    s_mov_b64 exec, -1
    v_mfma_f32_16x16x32_bf16 v[104:107], v[48:51], v[16:19], v[104:107]
    v_mfma_f32_16x16x32_bf16 v[108:111], v[48:51], v[20:23], v[108:111]
    v_mfma_f32_16x16x32_bf16 v[112:115], v[48:51], v[24:27], v[112:115]
    v_mfma_f32_16x16x32_bf16 v[116:119], v[48:51], v[28:31], v[116:119]
    s_waitcnt lgkmcnt(0)
    s_barrier
    ds_read_b64_tr_b16 v[48:49], v14 offset:0
    ds_read_b64_tr_b16 v[50:51], v14 offset:512
    ds_read_b128 v[16:19], v10 offset:0
    ds_read_b128 v[20:23], v10 offset:2048
    ds_read_b128 v[24:27], v10 offset:4096
    ds_read_b128 v[28:31], v10 offset:6144
    v_mfma_f32_16x16x32_bf16 v[104:107], v[60:63], v[32:35], v[104:107]
    v_mfma_f32_16x16x32_bf16 v[108:111], v[60:63], v[36:39], v[108:111]
    v_mfma_f32_16x16x32_bf16 v[112:115], v[60:63], v[40:43], v[112:115]
    v_mfma_f32_16x16x32_bf16 v[116:119], v[60:63], v[44:47], v[116:119]
    ds_read_b64_tr_b16 v[60:61], v14 offset:12288
    ds_read_b64_tr_b16 v[62:63], v14 offset:12800
    ds_read_b128 v[32:35], v11 offset:0
    ds_read_b128 v[36:39], v11 offset:2048
    ds_read_b128 v[40:43], v11 offset:4096
    ds_read_b128 v[44:47], v11 offset:6144
    s_waitcnt lgkmcnt(6)
    v_mfma_f32_16x16x32_bf16 v[104:107], v[48:51], v[16:19], v[104:107]
    v_mfma_f32_16x16x32_bf16 v[108:111], v[48:51], v[20:23], v[108:111]
    v_mfma_f32_16x16x32_bf16 v[112:115], v[48:51], v[24:27], v[112:115]
    v_mfma_f32_16x16x32_bf16 v[116:119], v[48:51], v[28:31], v[116:119]
    s_waitcnt lgkmcnt(0)
    s_mov_b64 exec, 1
    ds_add_u32 v88, v89 offset:0
    s_mov_b64 exec, -1
    v_mfma_f32_16x16x32_bf16 v[104:107], v[60:63], v[32:35], v[104:107]
    v_mfma_f32_16x16x32_bf16 v[108:111], v[60:63], v[36:39], v[108:111]
    v_mfma_f32_16x16x32_bf16 v[112:115], v[60:63], v[40:43], v[112:115]
    v_mfma_f32_16x16x32_bf16 v[116:119], v[60:63], v[44:47], v[116:119]
    s_nop 7
    v_mul_f32 v132, 0x3fb8aa3b, v104
    v_mul_f32 v133, 0x3fb8aa3b, v105
    v_mul_f32 v134, 0x3fb8aa3b, v106
    v_mul_f32 v135, 0x3fb8aa3b, v107
    v_mul_f32 v136, 0x3fb8aa3b, v108
    v_mul_f32 v137, 0x3fb8aa3b, v109
    v_mul_f32 v138, 0x3fb8aa3b, v110
    v_mul_f32 v139, 0x3fb8aa3b, v111
    v_exp_f32 v132, v132 clamp
    v_exp_f32 v133, v133 clamp
    v_exp_f32 v134, v134 clamp
    v_exp_f32 v135, v135 clamp
    v_exp_f32 v136, v136 clamp
    v_exp_f32 v137, v137 clamp
    v_exp_f32 v138, v138 clamp
    v_exp_f32 v139, v139 clamp
    v_max_f32 v104, 0, v104
    v_max_f32 v105, 0, v105
    v_max_f32 v106, 0, v106
    v_max_f32 v107, 0, v107
    v_max_f32 v108, 0, v108
    v_max_f32 v109, 0, v109
    v_max_f32 v110, 0, v110
    v_max_f32 v111, 0, v111
    v_add_f32 v132, 0x358637bd, v132
    v_add_f32 v133, 0x358637bd, v133
    v_add_f32 v134, 0x358637bd, v134
    v_add_f32 v135, 0x358637bd, v135
    v_add_f32 v136, 0x358637bd, v136
    v_add_f32 v137, 0x358637bd, v137
    v_add_f32 v138, 0x358637bd, v138
    v_add_f32 v139, 0x358637bd, v139
    v_add_f32 v104, v104, v132
    v_add_f32 v105, v105, v133
    v_add_f32 v106, v106, v134
    v_add_f32 v107, v107, v135
    v_add_f32 v108, v108, v136
    v_add_f32 v109, v109, v137
    v_add_f32 v110, v110, v138
    v_add_f32 v111, v111, v139
    v_mul_f32 v132, 0x3fb8aa3b, v112
    v_mul_f32 v133, 0x3fb8aa3b, v113
    v_mul_f32 v134, 0x3fb8aa3b, v114
    v_mul_f32 v135, 0x3fb8aa3b, v115
    v_mul_f32 v136, 0x3fb8aa3b, v116
    v_mul_f32 v137, 0x3fb8aa3b, v117
    v_mul_f32 v138, 0x3fb8aa3b, v118
    v_mul_f32 v139, 0x3fb8aa3b, v119
    v_exp_f32 v132, v132 clamp
    v_exp_f32 v133, v133 clamp
    v_exp_f32 v134, v134 clamp
    v_exp_f32 v135, v135 clamp
    v_exp_f32 v136, v136 clamp
    v_exp_f32 v137, v137 clamp
    v_exp_f32 v138, v138 clamp
    v_exp_f32 v139, v139 clamp
    v_max_f32 v112, 0, v112
    v_max_f32 v113, 0, v113
    v_max_f32 v114, 0, v114
    v_max_f32 v115, 0, v115
    v_max_f32 v116, 0, v116
    v_max_f32 v117, 0, v117
    v_max_f32 v118, 0, v118
    v_max_f32 v119, 0, v119
    v_add_f32 v132, 0x358637bd, v132
    v_add_f32 v133, 0x358637bd, v133
    v_add_f32 v134, 0x358637bd, v134
    v_add_f32 v135, 0x358637bd, v135
    v_add_f32 v136, 0x358637bd, v136
    v_add_f32 v137, 0x358637bd, v137
    v_add_f32 v138, 0x358637bd, v138
    v_add_f32 v139, 0x358637bd, v139
    v_add_f32 v112, v112, v132
    v_add_f32 v113, v113, v133
    v_add_f32 v114, v114, v134
    v_add_f32 v115, v115, v135
    v_add_f32 v116, v116, v136
    v_add_f32 v117, v117, v137
    v_add_f32 v118, v118, v138
    v_add_f32 v119, v119, v139
    v_cvt_pk_bf16_f32 v140, v104, v105
    v_cvt_pk_bf16_f32 v141, v106, v107
    v_cvt_pk_bf16_f32 v142, v108, v109
    v_cvt_pk_bf16_f32 v143, v110, v111
    v_cvt_pk_bf16_f32 v144, v112, v113
    v_cvt_pk_bf16_f32 v145, v114, v115
    v_cvt_pk_bf16_f32 v146, v116, v117
    v_cvt_pk_bf16_f32 v147, v118, v119
    s_nop 1
    v_permlane16_swap_b32 v140, v142
    v_permlane16_swap_b32 v141, v143
    v_permlane16_swap_b32 v144, v146
    v_permlane16_swap_b32 v145, v147
    buffer_store_dwordx4 v[140:143], v130, s[44:47], s62 offen sc1
    buffer_store_dwordx4 v[144:147], v130, s[44:47], s63 offen sc1
    v_lshrrev_b32 v6, 5, v1
    v_bfe_u32 v7, v1, 2, 2
    v_lshl_add_u32 v6, v6, 2, v7
    v_lshlrev_b32 v6, 7, v6
    v_and_b32 v2, 1, v1
    v_lshl_add_u32 v6, v2, 3, v6
    s_lshl_b32 s12, s3, 13
    s_add_u32 s13, s12, 81920
    v_add_u32 v6, s13, v6
    v_and_b32 v7, 2, v7
    v_lshlrev_b32 v7, 1, v7
    v_bfe_u32 v2, v1, 4, 1
    v_lshlrev_b32 v2, 1, v2
    v_xor_b32 v7, v7, v2
    v_bfe_u32 v2, v1, 1, 1
    v_xor_b32 v7, v7, v2
    v_lshl_add_u32 v3, v7, 4, v6
    v_xor_b32 v7, 4, v7
    v_lshl_add_u32 v4, v7, 4, v6
    s_sub_u32 s12, s3, s6
    s_add_u32 s12, s12, 7
    s_and_b32 s12, s12, 7
    s_lshl_b32 s12, s12, 12
    v_lshl_add_u32 v6, v1, 4, s12
    v_lshl_add_u32 v5, v1, 4, s96
    v_mov_b32 v8, 0
    v_mov_b32 v9, 0
    v_mov_b32 v10, 0
    v_mov_b32 v11, 0
    v_mov_b32 v12, 0
    v_mov_b32 v13, 0
    v_mov_b32 v14, 0
    v_mov_b32 v15, 0
    v_mov_b32 v16, 0
    v_mov_b32 v17, 0
    v_mov_b32 v18, 0
    v_mov_b32 v19, 0
    v_mov_b32 v20, 0
    v_mov_b32 v21, 0
    v_mov_b32 v22, 0
    v_mov_b32 v23, 0
    v_mov_b32 v24, 0
    v_mov_b32 v25, 0
    v_mov_b32 v26, 0
    v_mov_b32 v27, 0
    v_mov_b32 v28, 0
    v_mov_b32 v29, 0
    v_mov_b32 v30, 0
    v_mov_b32 v31, 0
    v_mov_b32 v32, 0
    v_mov_b32 v33, 0
    v_mov_b32 v34, 0
    v_mov_b32 v35, 0
    v_mov_b32 v36, 0
    v_mov_b32 v37, 0
    v_mov_b32 v38, 0
    v_mov_b32 v39, 0
    s_waitcnt vmcnt(0)
    s_mov_b64 exec, 1
    ds_add_rtn_u32 v7, v88, v89 offset:8
    s_mov_b64 exec, -1
    s_waitcnt lgkmcnt(0)
    v_readfirstlane_b32 s15, v7
    s_mov_b32 s14, 1
    s_cmp_lg_u32 s15, 7
    s_cbranch_scc1 Lc_na
    s_atomic_add s14, s[32:33], s61 glc
Lc_na:
    s_mov_b32 s11, 0x100000
Lw4:
    ds_read_b32 v2, v88 offset:0
    s_waitcnt lgkmcnt(0)
    v_readfirstlane_b32 s10, v2
    s_cmp_ge_u32 s10, 12
    s_cbranch_scc1 Lwd4
    s_sleep 1
    s_sub_u32 s11, s11, 1
    s_cmp_lg_u32 s11, 0
    s_cbranch_scc1 Lw4
Lwd4:
    ds_read_b64_tr_b16 v[40:41], v3 offset:0
    ds_read_b64_tr_b16 v[42:43], v3 offset:1024
    ds_read_b64_tr_b16 v[44:45], v4 offset:0
    ds_read_b64_tr_b16 v[46:47], v4 offset:1024
    ds_read_b64_tr_b16 v[48:49], v3 offset:2048
    ds_read_b64_tr_b16 v[50:51], v3 offset:3072
    ds_read_b64_tr_b16 v[52:53], v4 offset:2048
    ds_read_b64_tr_b16 v[54:55], v4 offset:3072
    ds_read_b64_tr_b16 v[56:57], v3 offset:4096
    ds_read_b64_tr_b16 v[58:59], v3 offset:5120
    ds_read_b64_tr_b16 v[60:61], v4 offset:4096
    ds_read_b64_tr_b16 v[62:63], v4 offset:5120
    ds_read_b64_tr_b16 v[64:65], v3 offset:6144
    ds_read_b64_tr_b16 v[66:67], v3 offset:7168
    ds_read_b64_tr_b16 v[68:69], v4 offset:6144
    ds_read_b64_tr_b16 v[70:71], v4 offset:7168
    s_waitcnt lgkmcnt(0)
    ds_write_b128 v6, v[40:43] offset:0
    ds_write_b128 v6, v[44:47] offset:1024
    ds_write_b128 v6, v[48:51] offset:2048
    ds_write_b128 v6, v[52:55] offset:3072
    ds_write_b128 v6, v[56:59] offset:32768
    ds_write_b128 v6, v[60:63] offset:33792
    ds_write_b128 v6, v[64:67] offset:34816
    ds_write_b128 v6, v[68:71] offset:35840
    s_mul_i32 s12, s8, 33792
    s_mul_i32 s13, s8, 81920
    s_add_u32 s13, s13, 65536
    v_lshl_add_u32 v3, v1, 4, s12
    v_xor_b32 v4, 0x400, v3
    v_lshl_add_u32 v2, v1, 4, s13
    s_waitcnt lgkmcnt(0)
    s_mov_b64 exec, 1
    ds_add_u32 v88, v89 offset:4
    s_mov_b64 exec, -1
    s_cmp_lg_u32 s15, 7
    s_cbranch_scc1 Lc_wp
    s_waitcnt lgkmcnt(0)
    s_cmp_eq_u32 s14, 7
    s_cbranch_scc1 Lc_pdone
    s_mov_b32 s11, 0x40000
Lg5:
    s_load_dword s10, s[32:33], s61 glc
    s_waitcnt lgkmcnt(0)
    s_cmp_ge_u32 s10, 8
    s_cbranch_scc1 Lgd5
    s_sub_u32 s11, s11, 1
    s_cmp_lg_u32 s11, 0
    s_cbranch_scc1 Lg5
Lgd5:
Lc_pdone:
    ds_write_b32 v88, v89 offset:12
    s_branch Lc_go
Lc_wp:
    s_mov_b32 s11, 0x100000
Lw6:
    ds_read_b32 v6, v88 offset:12
    s_waitcnt lgkmcnt(0)
    v_readfirstlane_b32 s10, v6
    s_cmp_ge_u32 s10, 1
    s_cbranch_scc1 Lwd6
    s_sleep 1
    s_sub_u32 s11, s11, 1
    s_cmp_lg_u32 s11, 0
    s_cbranch_scc1 Lw6
Lwd6:
Lc_go:
    buffer_load_dwordx4 v[104:107], v5, s[44:47], s88 offen offset:0 sc1
    buffer_load_dwordx4 v[108:111], v5, s[44:47], s88 offen offset:1024 sc1
    buffer_load_dwordx4 v[112:115], v5, s[44:47], s89 offen offset:0 sc1
    s_mov_b32 s11, 0x100000
Lw7:
    ds_read_b32 v6, v88 offset:4
    s_waitcnt lgkmcnt(0)
    v_readfirstlane_b32 s10, v6
    s_cmp_ge_u32 s10, 12
    s_cbranch_scc1 Lwd7
    s_sleep 1
    s_sub_u32 s11, s11, 1
    s_cmp_lg_u32 s11, 0
    s_cbranch_scc1 Lw7
Lwd7:
    buffer_load_dwordx4 v[116:119], v5, s[44:47], s89 offen offset:1024 sc1
    buffer_load_dwordx4 v[120:123], v5, s[44:47], s90 offen offset:0 sc1
    buffer_load_dwordx4 v[124:127], v5, s[44:47], s90 offen offset:1024 sc1
    ds_read_b128 v[72:75], v2 offset:0
    ds_read_b128 v[76:79], v2 offset:1024
    s_lshl_b32 s12, s3, 12
    s_add_u32 s12, s12, 81920
    v_lshl_add_u32 v6, v1, 4, s12
    s_xor_b32 s13, s3, 4
    s_lshl_b32 s13, s13, 12
    s_add_u32 s13, s13, 81920
    v_lshl_add_u32 v7, v1, 4, s13
    s_lshl_b32 s12, s5, 7
    s_lshl_b32 s13, s7, 5
    s_add_u32 s14, s12, s13
    s_lshl_b32 s12, s4, 10
    s_lshl_b32 s13, s6, 7
    s_add_u32 s12, s12, s13
    s_lshl_b32 s13, s8, 6
    s_add_u32 s12, s12, s13
    s_mul_i32 s15, s3, 2560
    s_add_u32 s15, s15, 0
    s_add_u32 s13, s12, 0x8000
    s_waitcnt vmcnt(5) lgkmcnt(1)
    v_mfma_f32_32x32x16_bf16 v[40:55], v[72:75], v[104:107], 0
    s_waitcnt vmcnt(4) lgkmcnt(0)
    v_mfma_f32_32x32x16_bf16 v[56:71], v[76:79], v[108:111], 0
    ds_read_b128 v[72:75], v2 offset:2048
    ds_read_b128 v[80:83], v3 offset:0
    ds_read_b128 v[84:87], v4 offset:0
    buffer_load_dwordx4 v[128:131], v5, s[44:47], s91 offen offset:0 sc1
    s_nop 7
    v_add_f32 v48, 0x358637bd, v48
    v_rcp_f32 v48, v48
    s_nop 0
    v_mul_f32 v40, v40, v48
    v_mul_f32 v41, v41, v48
    v_mul_f32 v42, v42, v48
    v_mul_f32 v43, v43, v48
    v_cvt_pk_bf16_f32 v96, v40, v41
    v_cvt_pk_bf16_f32 v97, v42, v43
    v_mul_f32 v44, v44, v48
    v_mul_f32 v45, v45, v48
    v_mul_f32 v46, v46, v48
    v_mul_f32 v47, v47, v48
    v_cvt_pk_bf16_f32 v98, v44, v45
    v_cvt_pk_bf16_f32 v99, v46, v47
    s_waitcnt vmcnt(4) lgkmcnt(0)
    v_mfma_f32_32x32x16_bf16 v[40:55], v[72:75], v[112:115], 0
    v_add_f32 v64, 0x358637bd, v64
    v_rcp_f32 v64, v64
    ds_read_b128 v[76:79], v2 offset:3072
    ds_read_b128 v[88:91], v3 offset:2048
    ds_read_b128 v[92:95], v4 offset:2048
    buffer_load_dwordx4 v[132:135], v5, s[44:47], s91 offen offset:1024 sc1
    v_mfma_f32_32x32x16_bf16 v[8:23], v[80:83], v[96:99], v[8:23]
    v_mul_f32 v56, v56, v64
    v_mul_f32 v57, v57, v64
    v_mul_f32 v58, v58, v64
    v_mul_f32 v59, v59, v64
    v_cvt_pk_bf16_f32 v100, v56, v57
    v_cvt_pk_bf16_f32 v101, v58, v59
    v_mfma_f32_32x32x16_bf16 v[24:39], v[84:87], v[96:99], v[24:39]
    v_mul_f32 v60, v60, v64
    v_mul_f32 v61, v61, v64
    v_mul_f32 v62, v62, v64
    v_mul_f32 v63, v63, v64
    v_cvt_pk_bf16_f32 v102, v60, v61
    v_cvt_pk_bf16_f32 v103, v62, v63
    s_waitcnt vmcnt(4) lgkmcnt(0)
    v_mfma_f32_32x32x16_bf16 v[56:71], v[76:79], v[116:119], 0
    v_add_f32 v48, 0x358637bd, v48
    v_rcp_f32 v48, v48
    ds_read_b128 v[72:75], v2 offset:4096
    ds_read_b128 v[80:83], v3 offset:4096
    ds_read_b128 v[84:87], v4 offset:4096
    buffer_load_dwordx4 v[136:139], v5, s[44:47], s92 offen offset:0 sc1
    v_mfma_f32_32x32x16_bf16 v[8:23], v[88:91], v[100:103], v[8:23]
    v_mul_f32 v40, v40, v48
    v_mul_f32 v41, v41, v48
    v_mul_f32 v42, v42, v48
    v_mul_f32 v43, v43, v48
    v_cvt_pk_bf16_f32 v96, v40, v41
    v_cvt_pk_bf16_f32 v97, v42, v43
    v_mfma_f32_32x32x16_bf16 v[24:39], v[92:95], v[100:103], v[24:39]
    v_mul_f32 v44, v44, v48
    v_mul_f32 v45, v45, v48
    v_mul_f32 v46, v46, v48
    v_mul_f32 v47, v47, v48
    v_cvt_pk_bf16_f32 v98, v44, v45
    v_cvt_pk_bf16_f32 v99, v46, v47
    s_waitcnt vmcnt(4) lgkmcnt(0)
    v_mfma_f32_32x32x16_bf16 v[40:55], v[72:75], v[120:123], 0
    v_add_f32 v64, 0x358637bd, v64
    v_rcp_f32 v64, v64
    ds_read_b128 v[76:79], v2 offset:5120
    ds_read_b128 v[88:91], v3 offset:6144
    ds_read_b128 v[92:95], v4 offset:6144
    buffer_load_dwordx4 v[140:143], v5, s[44:47], s92 offen offset:1024 sc1
    v_mfma_f32_32x32x16_bf16 v[8:23], v[80:83], v[96:99], v[8:23]
    v_mul_f32 v56, v56, v64
    v_mul_f32 v57, v57, v64
    v_mul_f32 v58, v58, v64
    v_mul_f32 v59, v59, v64
    v_cvt_pk_bf16_f32 v100, v56, v57
    v_cvt_pk_bf16_f32 v101, v58, v59
    v_mfma_f32_32x32x16_bf16 v[24:39], v[84:87], v[96:99], v[24:39]
    v_mul_f32 v60, v60, v64
    v_mul_f32 v61, v61, v64
    v_mul_f32 v62, v62, v64
    v_mul_f32 v63, v63, v64
    v_cvt_pk_bf16_f32 v102, v60, v61
    v_cvt_pk_bf16_f32 v103, v62, v63
    s_waitcnt vmcnt(4) lgkmcnt(0)
    v_mfma_f32_32x32x16_bf16 v[56:71], v[76:79], v[124:127], 0
    v_add_f32 v48, 0x358637bd, v48
    v_rcp_f32 v48, v48
    ds_read_b128 v[72:75], v2 offset:6144
    ds_read_b128 v[80:83], v3 offset:8192
    ds_read_b128 v[84:87], v4 offset:8192
    buffer_load_dwordx4 v[144:147], v5, s[44:47], s93 offen offset:0 sc1
    v_mfma_f32_32x32x16_bf16 v[8:23], v[88:91], v[100:103], v[8:23]
    v_mul_f32 v40, v40, v48
    v_mul_f32 v41, v41, v48
    v_mul_f32 v42, v42, v48
    v_mul_f32 v43, v43, v48
    v_cvt_pk_bf16_f32 v96, v40, v41
    v_cvt_pk_bf16_f32 v97, v42, v43
    v_mfma_f32_32x32x16_bf16 v[24:39], v[92:95], v[100:103], v[24:39]
    v_mul_f32 v44, v44, v48
    v_mul_f32 v45, v45, v48
    v_mul_f32 v46, v46, v48
    v_mul_f32 v47, v47, v48
    v_cvt_pk_bf16_f32 v98, v44, v45
    v_cvt_pk_bf16_f32 v99, v46, v47
    s_waitcnt vmcnt(4) lgkmcnt(0)
    v_mfma_f32_32x32x16_bf16 v[40:55], v[72:75], v[128:131], 0
    v_add_f32 v64, 0x358637bd, v64
    v_rcp_f32 v64, v64
    ds_read_b128 v[76:79], v2 offset:7168
    ds_read_b128 v[88:91], v3 offset:10240
    ds_read_b128 v[92:95], v4 offset:10240
    buffer_load_dwordx4 v[148:151], v5, s[44:47], s93 offen offset:1024 sc1
    v_mfma_f32_32x32x16_bf16 v[8:23], v[80:83], v[96:99], v[8:23]
    v_mul_f32 v56, v56, v64
    v_mul_f32 v57, v57, v64
    v_mul_f32 v58, v58, v64
    v_mul_f32 v59, v59, v64
    v_cvt_pk_bf16_f32 v100, v56, v57
    v_cvt_pk_bf16_f32 v101, v58, v59
    v_mfma_f32_32x32x16_bf16 v[24:39], v[84:87], v[96:99], v[24:39]
    v_mul_f32 v60, v60, v64
    v_mul_f32 v61, v61, v64
    v_mul_f32 v62, v62, v64
    v_mul_f32 v63, v63, v64
    v_cvt_pk_bf16_f32 v102, v60, v61
    v_cvt_pk_bf16_f32 v103, v62, v63
    s_waitcnt vmcnt(4) lgkmcnt(0)
    v_mfma_f32_32x32x16_bf16 v[56:71], v[76:79], v[132:135], 0
    v_add_f32 v48, 0x358637bd, v48
    v_rcp_f32 v48, v48
    ds_read_b128 v[72:75], v2 offset:8192
    ds_read_b128 v[80:83], v3 offset:12288
    ds_read_b128 v[84:87], v4 offset:12288
    buffer_load_dwordx4 v[152:155], v5, s[44:47], s94 offen offset:0 sc1
    v_mfma_f32_32x32x16_bf16 v[8:23], v[88:91], v[100:103], v[8:23]
    v_mul_f32 v40, v40, v48
    v_mul_f32 v41, v41, v48
    v_mul_f32 v42, v42, v48
    v_mul_f32 v43, v43, v48
    v_cvt_pk_bf16_f32 v96, v40, v41
    v_cvt_pk_bf16_f32 v97, v42, v43
    v_mfma_f32_32x32x16_bf16 v[24:39], v[92:95], v[100:103], v[24:39]
    v_mul_f32 v44, v44, v48
    v_mul_f32 v45, v45, v48
    v_mul_f32 v46, v46, v48
    v_mul_f32 v47, v47, v48
    v_cvt_pk_bf16_f32 v98, v44, v45
    v_cvt_pk_bf16_f32 v99, v46, v47
    s_waitcnt vmcnt(4) lgkmcnt(0)
    v_mfma_f32_32x32x16_bf16 v[40:55], v[72:75], v[136:139], 0
    v_add_f32 v64, 0x358637bd, v64
    v_rcp_f32 v64, v64
    ds_read_b128 v[76:79], v2 offset:9216
    ds_read_b128 v[88:91], v3 offset:14336
    ds_read_b128 v[92:95], v4 offset:14336
    buffer_load_dwordx4 v[156:159], v5, s[44:47], s94 offen offset:1024 sc1
    v_mfma_f32_32x32x16_bf16 v[8:23], v[80:83], v[96:99], v[8:23]
    v_mul_f32 v56, v56, v64
    v_mul_f32 v57, v57, v64
    v_mul_f32 v58, v58, v64
    v_mul_f32 v59, v59, v64
    v_cvt_pk_bf16_f32 v100, v56, v57
    v_cvt_pk_bf16_f32 v101, v58, v59
    v_mfma_f32_32x32x16_bf16 v[24:39], v[84:87], v[96:99], v[24:39]
    v_mul_f32 v60, v60, v64
    v_mul_f32 v61, v61, v64
    v_mul_f32 v62, v62, v64
    v_mul_f32 v63, v63, v64
    v_cvt_pk_bf16_f32 v102, v60, v61
    v_cvt_pk_bf16_f32 v103, v62, v63
    s_waitcnt vmcnt(4) lgkmcnt(0)
    v_mfma_f32_32x32x16_bf16 v[56:71], v[76:79], v[140:143], 0
    v_add_f32 v48, 0x358637bd, v48
    v_rcp_f32 v48, v48
    ds_read_b128 v[72:75], v2 offset:10240
    ds_read_b128 v[80:83], v3 offset:16384
    ds_read_b128 v[84:87], v4 offset:16384
    buffer_load_dwordx4 v[160:163], v5, s[44:47], s95 offen offset:0 sc1
    v_mfma_f32_32x32x16_bf16 v[8:23], v[88:91], v[100:103], v[8:23]
    v_mul_f32 v40, v40, v48
    v_mul_f32 v41, v41, v48
    v_mul_f32 v42, v42, v48
    v_mul_f32 v43, v43, v48
    v_cvt_pk_bf16_f32 v96, v40, v41
    v_cvt_pk_bf16_f32 v97, v42, v43
    v_mfma_f32_32x32x16_bf16 v[24:39], v[92:95], v[100:103], v[24:39]
    v_mul_f32 v44, v44, v48
    v_mul_f32 v45, v45, v48
    v_mul_f32 v46, v46, v48
    v_mul_f32 v47, v47, v48
    v_cvt_pk_bf16_f32 v98, v44, v45
    v_cvt_pk_bf16_f32 v99, v46, v47
    s_waitcnt vmcnt(4) lgkmcnt(0)
    v_mfma_f32_32x32x16_bf16 v[40:55], v[72:75], v[144:147], 0
    v_add_f32 v64, 0x358637bd, v64
    v_rcp_f32 v64, v64
    ds_read_b128 v[76:79], v2 offset:11264
    ds_read_b128 v[88:91], v3 offset:18432
    ds_read_b128 v[92:95], v4 offset:18432
    buffer_load_dwordx4 v[164:167], v5, s[44:47], s95 offen offset:1024 sc1
    v_mfma_f32_32x32x16_bf16 v[8:23], v[80:83], v[96:99], v[8:23]
    v_mul_f32 v56, v56, v64
    v_mul_f32 v57, v57, v64
    v_mul_f32 v58, v58, v64
    v_mul_f32 v59, v59, v64
    v_cvt_pk_bf16_f32 v100, v56, v57
    v_cvt_pk_bf16_f32 v101, v58, v59
    v_mfma_f32_32x32x16_bf16 v[24:39], v[84:87], v[96:99], v[24:39]
    v_mul_f32 v60, v60, v64
    v_mul_f32 v61, v61, v64
    v_mul_f32 v62, v62, v64
    v_mul_f32 v63, v63, v64
    v_cvt_pk_bf16_f32 v102, v60, v61
    v_cvt_pk_bf16_f32 v103, v62, v63
    s_waitcnt vmcnt(4) lgkmcnt(0)
    v_mfma_f32_32x32x16_bf16 v[56:71], v[76:79], v[148:151], 0
    v_add_f32 v48, 0x358637bd, v48
    v_rcp_f32 v48, v48
    ds_read_b128 v[72:75], v2 offset:12288
    ds_read_b128 v[80:83], v3 offset:20480
    ds_read_b128 v[84:87], v4 offset:20480
    v_mfma_f32_32x32x16_bf16 v[8:23], v[88:91], v[100:103], v[8:23]
    v_mul_f32 v40, v40, v48
    v_mul_f32 v41, v41, v48
    v_mul_f32 v42, v42, v48
    v_mul_f32 v43, v43, v48
    v_cvt_pk_bf16_f32 v96, v40, v41
    v_cvt_pk_bf16_f32 v97, v42, v43
    v_mfma_f32_32x32x16_bf16 v[24:39], v[92:95], v[100:103], v[24:39]
    v_mul_f32 v44, v44, v48
    v_mul_f32 v45, v45, v48
    v_mul_f32 v46, v46, v48
    v_mul_f32 v47, v47, v48
    v_cvt_pk_bf16_f32 v98, v44, v45
    v_cvt_pk_bf16_f32 v99, v46, v47
    s_waitcnt vmcnt(3) lgkmcnt(0)
    v_mfma_f32_32x32x16_bf16 v[40:55], v[72:75], v[152:155], 0
    v_add_f32 v64, 0x358637bd, v64
    v_rcp_f32 v64, v64
    ds_read_b128 v[76:79], v2 offset:13312
    ds_read_b128 v[88:91], v3 offset:22528
    ds_read_b128 v[92:95], v4 offset:22528
    v_mfma_f32_32x32x16_bf16 v[8:23], v[80:83], v[96:99], v[8:23]
    v_mul_f32 v56, v56, v64
    v_mul_f32 v57, v57, v64
    v_mul_f32 v58, v58, v64
    v_mul_f32 v59, v59, v64
    v_cvt_pk_bf16_f32 v100, v56, v57
    v_cvt_pk_bf16_f32 v101, v58, v59
    v_mfma_f32_32x32x16_bf16 v[24:39], v[84:87], v[96:99], v[24:39]
    v_mul_f32 v60, v60, v64
    v_mul_f32 v61, v61, v64
    v_mul_f32 v62, v62, v64
    v_mul_f32 v63, v63, v64
    v_cvt_pk_bf16_f32 v102, v60, v61
    v_cvt_pk_bf16_f32 v103, v62, v63
    s_waitcnt vmcnt(2) lgkmcnt(0)
    v_mfma_f32_32x32x16_bf16 v[56:71], v[76:79], v[156:159], 0
    v_add_f32 v48, 0x358637bd, v48
    v_rcp_f32 v48, v48
    ds_read_b128 v[72:75], v2 offset:14336
    ds_read_b128 v[80:83], v3 offset:24576
    ds_read_b128 v[84:87], v4 offset:24576
    v_mfma_f32_32x32x16_bf16 v[8:23], v[88:91], v[100:103], v[8:23]
    v_mul_f32 v40, v40, v48
    v_mul_f32 v41, v41, v48
    v_mul_f32 v42, v42, v48
    v_mul_f32 v43, v43, v48
    v_cvt_pk_bf16_f32 v96, v40, v41
    v_cvt_pk_bf16_f32 v97, v42, v43
    v_mfma_f32_32x32x16_bf16 v[24:39], v[92:95], v[100:103], v[24:39]
    v_mul_f32 v44, v44, v48
    v_mul_f32 v45, v45, v48
    v_mul_f32 v46, v46, v48
    v_mul_f32 v47, v47, v48
    v_cvt_pk_bf16_f32 v98, v44, v45
    v_cvt_pk_bf16_f32 v99, v46, v47
    s_waitcnt vmcnt(1) lgkmcnt(0)
    v_mfma_f32_32x32x16_bf16 v[40:55], v[72:75], v[160:163], 0
    v_add_f32 v64, 0x358637bd, v64
    v_rcp_f32 v64, v64
    ds_read_b128 v[76:79], v2 offset:15360
    ds_read_b128 v[88:91], v3 offset:26624
    ds_read_b128 v[92:95], v4 offset:26624
    v_mfma_f32_32x32x16_bf16 v[8:23], v[80:83], v[96:99], v[8:23]
    v_mul_f32 v56, v56, v64
    v_mul_f32 v57, v57, v64
    v_mul_f32 v58, v58, v64
    v_mul_f32 v59, v59, v64
    v_cvt_pk_bf16_f32 v100, v56, v57
    v_cvt_pk_bf16_f32 v101, v58, v59
    v_mfma_f32_32x32x16_bf16 v[24:39], v[84:87], v[96:99], v[24:39]
    v_mul_f32 v60, v60, v64
    v_mul_f32 v61, v61, v64
    v_mul_f32 v62, v62, v64
    v_mul_f32 v63, v63, v64
    v_cvt_pk_bf16_f32 v102, v60, v61
    v_cvt_pk_bf16_f32 v103, v62, v63
    s_waitcnt vmcnt(0) lgkmcnt(0)
    v_mfma_f32_32x32x16_bf16 v[56:71], v[76:79], v[164:167], 0
    v_add_f32 v48, 0x358637bd, v48
    v_rcp_f32 v48, v48
    ds_read_b128 v[80:83], v3 offset:28672
    ds_read_b128 v[84:87], v4 offset:28672
    v_mfma_f32_32x32x16_bf16 v[8:23], v[88:91], v[100:103], v[8:23]
    v_mul_f32 v40, v40, v48
    v_mul_f32 v41, v41, v48
    v_mul_f32 v42, v42, v48
    v_mul_f32 v43, v43, v48
    v_cvt_pk_bf16_f32 v96, v40, v41
    v_cvt_pk_bf16_f32 v97, v42, v43
    v_mfma_f32_32x32x16_bf16 v[24:39], v[92:95], v[100:103], v[24:39]
    v_mul_f32 v44, v44, v48
    v_mul_f32 v45, v45, v48
    v_mul_f32 v46, v46, v48
    v_mul_f32 v47, v47, v48
    v_cvt_pk_bf16_f32 v98, v44, v45
    v_cvt_pk_bf16_f32 v99, v46, v47
    s_waitcnt lgkmcnt(0)
    v_add_f32 v64, 0x358637bd, v64
    v_rcp_f32 v64, v64
    ds_read_b128 v[88:91], v3 offset:30720
    ds_read_b128 v[92:95], v4 offset:30720
    v_mfma_f32_32x32x16_bf16 v[8:23], v[80:83], v[96:99], v[8:23]
    v_mul_f32 v56, v56, v64
    v_mul_f32 v57, v57, v64
    v_mul_f32 v58, v58, v64
    v_mul_f32 v59, v59, v64
    v_cvt_pk_bf16_f32 v100, v56, v57
    v_cvt_pk_bf16_f32 v101, v58, v59
    v_mfma_f32_32x32x16_bf16 v[24:39], v[84:87], v[96:99], v[24:39]
    v_mul_f32 v60, v60, v64
    v_mul_f32 v61, v61, v64
    v_mul_f32 v62, v62, v64
    v_mul_f32 v63, v63, v64
    v_cvt_pk_bf16_f32 v102, v60, v61
    v_cvt_pk_bf16_f32 v103, v62, v63
    v_lshrrev_b32 v2, 5, v1
    v_and_b32 v104, 31, v1
    v_mul_u32_u24 v104, 80, v104
    v_lshl_add_u32 v104, v2, 3, v104
    v_add_u32 v104, s15, v104
    v_lshrrev_b32 v106, 2, v1
    v_and_b32 v107, 3, v1
    v_mul_u32_u24 v105, 80, v106
    v_lshl_add_u32 v105, v107, 4, v105
    v_add_u32 v105, s15, v105
    v_add_u32 v5, s14, v106
    v_lshlrev_b32 v5, 11, v5
    v_lshl_add_u32 v5, v107, 4, v5
    s_waitcnt lgkmcnt(0)
    v_mfma_f32_32x32x16_bf16 v[24:39], v[92:95], v[100:103], v[24:39]
    v_mfma_f32_32x32x16_bf16 v[8:23], v[88:91], v[100:103], v[8:23]
    s_nop 10
    ds_write_b128 v6, v[24:27] offset:0
    ds_write_b128 v6, v[28:31] offset:1024
    ds_write_b128 v6, v[32:35] offset:2048
    ds_write_b128 v6, v[36:39] offset:3072
    s_waitcnt lgkmcnt(0)
    s_barrier
    ds_read_b128 v[40:43], v7 offset:0
    ds_read_b128 v[44:47], v7 offset:1024
    ds_read_b128 v[48:51], v7 offset:2048
    ds_read_b128 v[52:55], v7 offset:3072
    s_waitcnt lgkmcnt(3)
    v_add_f32 v8, v8, v40
    v_add_f32 v9, v9, v41
    v_add_f32 v10, v10, v42
    v_add_f32 v11, v11, v43
    v_cvt_pk_bf16_f32 v56, v8, v9
    v_cvt_pk_bf16_f32 v57, v10, v11
    ds_write_b64 v104, v[56:57] offset:0
    s_waitcnt lgkmcnt(3)
    v_add_f32 v12, v12, v44
    v_add_f32 v13, v13, v45
    v_add_f32 v14, v14, v46
    v_add_f32 v15, v15, v47
    v_cvt_pk_bf16_f32 v58, v12, v13
    v_cvt_pk_bf16_f32 v59, v14, v15
    ds_write_b64 v104, v[58:59] offset:16
    s_waitcnt lgkmcnt(3)
    v_add_f32 v16, v16, v48
    v_add_f32 v17, v17, v49
    v_add_f32 v18, v18, v50
    v_add_f32 v19, v19, v51
    v_cvt_pk_bf16_f32 v60, v16, v17
    v_cvt_pk_bf16_f32 v61, v18, v19
    ds_write_b64 v104, v[60:61] offset:32
    s_waitcnt lgkmcnt(3)
    v_add_f32 v20, v20, v52
    v_add_f32 v21, v21, v53
    v_add_f32 v22, v22, v54
    v_add_f32 v23, v23, v55
    v_cvt_pk_bf16_f32 v62, v20, v21
    v_cvt_pk_bf16_f32 v63, v22, v23
    ds_write_b64 v104, v[62:63] offset:48
    ds_read_b128 v[40:43], v105 offset:0
    ds_read_b128 v[44:47], v105 offset:1280
    s_waitcnt lgkmcnt(1)
    buffer_store_dwordx4 v[40:43], v5, s[56:59], s12 offen sc1
    s_waitcnt lgkmcnt(0)
    buffer_store_dwordx4 v[44:47], v5, s[56:59], s13 offen sc1
Lend:
    s_endpgm
Lcode_end:
.section .rodata,"a"
.p2align 6
.amdhsa_kernel concat_heads__linear_attn_block__linear_attn_block__prompt_kernel
  .amdhsa_next_free_vgpr 168
  .amdhsa_next_free_sgpr 100
  .amdhsa_accum_offset 168
  .amdhsa_group_segment_fixed_size 0
  .amdhsa_kernarg_size 72
  .amdhsa_user_sgpr_count 2
  .amdhsa_user_sgpr_kernarg_segment_ptr 1
  .amdhsa_system_sgpr_workgroup_id_x 1
.end_amdhsa_kernel
```
